```python
import torch

def _softmax(x, axis=-1):
    return torch.softmax(x, dim=axis)
def _gelu(x):
    return torch.nn.functional.gelu(x, approximate="tanh")
def _silu(x):
    return torch.nn.functional.silu(x)
def _sigmoid(x):
    return torch.sigmoid(x)
def _layernorm(x, axis=-1, eps=1e-5):
    m = x.mean(dim=axis, keepdim=True)
    v = x.var(dim=axis, keepdim=True, unbiased=False)
    return (x - m) / torch.sqrt(v + eps)
def _scatter_add(tgt, idx, src, axis=0):
    return tgt.clone().index_add_(axis, idx, src)
def _segment_sum(src, seg, n):
    out = torch.zeros((n,) + src.shape[1:], dtype=src.dtype)
    return out.index_add_(0, seg, src)
def _pad(x, pw):
    flat = tuple(v for pair in reversed(pw) for v in pair)
    return torch.nn.functional.pad(x, flat)

kernel_name = 'parallel_sum__ssm_conv_h3__dense_activation_relu__prompt'

def setup_inputs():

    _w = (lambda a: (lambda t: t.to(torch.bfloat16) if t.is_floating_point() else t)(torch.as_tensor(a)))
    def _A_setup():
        B, S, D = 1, 2048, 448
        ks = 4
        return {
            "q": _w((lambda *s: torch.randn(*s, dtype=torch.bfloat16) * 0.05)(B, S, D)),
            "k": _w((lambda *s: torch.randn(*s, dtype=torch.bfloat16) * 0.8)(B, S, D)),
            "v": _w((lambda *s: torch.randn(*s, dtype=torch.bfloat16) * 0.8)(B, S, D)),
            "shift_k": _w((lambda *s: torch.randn(*s, dtype=torch.bfloat16) * 0.8)(D, ks) * 0.5),
            "ssm_k": _w((lambda *s: torch.randn(*s, dtype=torch.bfloat16) * 0.8)(D, S) * (1.0 / S ** 0.5)),
            "ssm_D": _w((lambda *s: torch.randn(*s, dtype=torch.bfloat16) * 0.8)(D)),
        }
    _A_in = _A_setup()

    def _B_setup():
        B, S, D, Dff = 1, 2048, 448, 1792
        return {
            "x": _w((lambda *s: torch.randn(*s, dtype=torch.bfloat16) * 0.05)(B, S, D)),
            "w1": _w((lambda *s: torch.randn(*s, dtype=torch.bfloat16) * 0.05)(D, Dff)),
            "w2": _w((lambda *s: torch.randn(*s, dtype=torch.bfloat16) * 0.05)(Dff, D)),
        }
    _B_in = _B_setup()

    return {
        "A_q": _A_in["q"],
        "A_k": _A_in["k"],
        "A_v": _A_in["v"],
        "A_shift_k": _A_in["shift_k"],
        "A_ssm_k": _A_in["ssm_k"],
        "A_ssm_D": _A_in["ssm_D"],
        "B_x": _B_in["x"],
        "B_w1": _B_in["w1"],
        "B_w2": _B_in["w2"],
    }

def reference(A_q, A_k, A_v, A_shift_k, A_ssm_k, A_ssm_D, B_x, B_w1, B_w2):
    def _A_ref(q, k, v, shift_k, ssm_k, ssm_D):
        B, S, D = q.shape
        ks = shift_k.shape[-1]
        k_pad = _pad(k, ((0, 0), (ks - 1, 0), (0, 0)))
        k_shift = torch.zeros_like(k)
        for t in range(ks):
            k_shift = k_shift + k_pad[:, t:t + S, :] * shift_k[:, ks - 1 - t][None, None, :]
        kv = k_shift * v
        L = 2 * S
        kv_pad = _pad(kv, ((0, 0), (0, S), (0, 0)))
        kf_pad = _pad(ssm_k, ((0, 0), (0, S)))
        kv_f = (lambda x, axes=(-2,-1): torch.fft.rfft2(x.float(), dim=axes))(kv_pad[:, None, :, :], axes=(1, 2))
        kf_f = (lambda x, axes=(-2,-1): torch.fft.rfft2(x.float(), dim=axes))(kf_pad[:, None, :], axes=(1, 2))
        kf_f = (lambda x, *d: x.permute(*d))(kf_f, 1, 2, 0)
        y_f = kv_f * kf_f[None, :, :, :]
        y = (lambda x, s, axes=(-2,-1): torch.fft.irfft2(x, s=s, dim=axes).to(torch.bfloat16))(y_f, (1, L), axes=(1, 2))[:, 0, :S, :]
        y = y + kv * ssm_D[None, None, :]
        return q * y

    def _B_ref(x, w1, w2):
        h = torch.einsum("bsd,df->bsf", x, w1)
        zero = torch.zeros_like(h)
        h = torch.maximum(h, zero)
        return torch.einsum("bsf,fd->bsd", h, w2)

    x = A_q
    xn = _layernorm(x, axis=-1)
    return x + _A_ref(xn, A_k, A_v, A_shift_k, A_ssm_k, A_ssm_D) + _B_ref(xn, B_w1, B_w2)
```

```asm
; @launch grid=(256,1,1) block=(256,1,1) lds=152832
.amdgcn_target "amdgcn-amd-amdhsa--gfx950"
.text
.globl parallel_sum__ssm_conv_h3__dense_activation_relu__prompt_kernel
.p2align 12
.fill 832, 4, 0xbf800000
.p2align 8
.type parallel_sum__ssm_conv_h3__dense_activation_relu__prompt_kernel,@function
parallel_sum__ssm_conv_h3__dense_activation_relu__prompt_kernel:
  s_load_dwordx16 s[4:19], s[0:1], 0
  s_load_dwordx8 s[20:27], s[0:1], 64
  v_lshrrev_b32 v1, 6, v0
  s_cmp_ge_u32 s2, 224
  s_cbranch_scc1 HELPER
  v_readfirstlane_b32 s60, v1
  v_and_b32 v0, 63, v0
  s_and_b32 s70, s2, 7
  s_lshr_b32 s71, s2, 3
  s_cmp_lg_u32 s60, 3
  s_cbranch_scc1 NOPF
  s_getpc_b64 s[96:97]
PCREF:
  s_mul_i32 s3, s71, 768
  v_lshl_add_u32 v2, v0, 7, s3
  v_add_u32 v2, 384, v2
  v_min_u32 v2, CODE_END-PCREF-4, v2
  s_mov_b64 exec, 63
  global_load_dword v5, v2, s[96:97]
  s_mov_b64 exec, -1
NOPF:
  s_mul_i32 s72, s71, 37
  s_lshr_b32 s72, s72, 8
  s_mul_i32 s3, s72, 7
  s_sub_u32 s62, s71, s3
  s_lshr_b32 s94, s70, 1
  s_lshl_b32 s94, s94, 2
  s_add_u32 s94, s94, s72
  s_and_b32 s95, s70, 1
  v_lshrrev_b32 v6, 3, v0
  v_and_b32 v7, 7, v0
  v_lshrrev_b32 v8, 4, v0
  v_mul_u32_u24 v4, 896, v6
  v_xor_b32 v2, v7, v8
  v_lshl_add_u32 v12, v2, 4, v4
  v_xor_b32 v2, 4, v2
  v_lshl_add_u32 v13, v2, 4, v4
  v_add_u32 v14, 12288, v12
  v_add_u32 v15, 18432, v13
  v_add_u32 v13, 6144, v13
  v_mul_u32_u24 v1, 3584, v8
  v_and_b32 v2, 15, v0
  v_lshlrev_b32 v3, 2, v8
  v_xor_b32 v2, v2, v3
  v_lshl_add_u32 v16, v2, 4, v1
  v_add_u32 v17, 13312, v16
  v_xor_b32 v19, 32, v16
  v_add_u32 v18, 26624, v19
  v_add_u32 v19, 39936, v19
  s_lshl_b32 s63, s94, 2
  s_add_u32 s63, s63, s60
  s_mul_i32 s63, s63, 28672
  s_mul_i32 s64, s60, 57344
  s_mul_i32 s71, s95, 7
  s_add_u32 s71, s71, s62
  s_lshl_b32 s71, s71, 8
  s_add_u32 s64, s64, s71
  s_lshl_b32 s66, s60, 12
  s_add_u32 s65, s62, s72
  s_and_b32 s65, s65, 1
  s_lshl_b32 s65, s65, 2
  s_lshr_b32 s3, s70, 1
  s_and_b32 s71, s70, 1
  s_lshl_b32 s71, s71, 1
  s_xor_b32 s3, s3, s71
  s_add_u32 s65, s65, s3
  s_mul_i32 s71, s65, 37
  s_lshr_b32 s71, s71, 8
  s_mul_i32 s71, s71, 7
  s_sub_u32 s65, s65, s71
  s_lshl_b32 s71, s65, 7
  s_add_u32 s63, s63, s71
  s_mul_i32 s71, s65, 229376
  s_add_u32 s64, s64, s71
  s_sub_u32 s74, s62, s65
  s_cselect_b32 s3, 7, 0
  s_add_u32 s74, s74, s3
  s_mov_b32 s30, 1835008
  s_mov_b32 s31, 0x20000
  s_mov_b32 s42, 1605632
  s_mov_b32 s43, 0x20000
  s_movk_i32 s68, 128
  s_mov_b32 s69, 229376
  s_lshl_b32 s61, s94, 1
  s_add_u32 s61, s61, s95
  s_lshl_b32 s67, s60, 13
  v_lshl_add_u32 v20, v7, 4, v4
  v_add_u32 v21, 6128, v20
  s_lshl_b32 s75, s61, 2
  s_add_u32 s75, s75, s60
  s_mul_i32 s75, s75, 14336
  s_lshl_b32 s71, s62, 7
  s_add_u32 s75, s75, s71
  s_mul_i32 s76, s60, 2080
  s_cmp_eq_u32 s61, 0
  s_cselect_b32 s71, 0x40000000, 0
  s_cselect_b32 s77, 0, 7168
  s_sub_u32 s77, s75, s77
  s_mul_i32 s3, s60, 14336
  s_sub_u32 s77, s77, s3
  v_subrev_u32 v22, 32, v0
  v_and_b32 v22, 0x40000000, v22
  v_or_b32 v22, s71, v22
  v_add_u32 v22, v22, v20
  s_lshl_b32 s71, s60, 3
  v_add_u32 v11, s71, v6
  s_lshl_b32 s71, s62, 5
  v_add_lshl_u32 v24, v0, s71, 4
  v_lshlrev_b32 v10, 4, v0
  s_add_u32 s73, s71, s61
  s_lshl_b32 s73, s73, 2
  s_add_u32 s73, s73, s60
  s_lshl_b32 s73, s73, 11
  s_mov_b32 s50, 1835008
  s_mov_b32 s51, 0x20000
  s_mov_b32 s34, 1835008
  s_mov_b32 s35, 0x20000
  s_mov_b32 s38, 1835008
  s_mov_b32 s39, 0x20000
  s_waitcnt lgkmcnt(0)
  s_mov_b64 s[32:33], s[6:7]
  s_mov_b64 s[36:37], s[8:9]
  s_mov_b64 s[28:29], s[4:5]
  s_mov_b64 s[40:41], s[18:19]
  s_mov_b64 s[48:49], s[12:13]
  buffer_load_dwordx4 v[240:243], v10, s[48:51], s73 offen offset:0
  buffer_load_dwordx4 v[248:251], v10, s[48:51], s73 offen offset:1024
  s_cmp_lg_u32 s60, 2
  s_cbranch_scc1 NOHALO2
  s_mov_b32 m0, 151040
  s_mov_b32 exec_hi, 0
  global_load_lds_dwordx4 v24, s[10:11]
  s_mov_b64 exec, -1
NOHALO2:
  s_cmp_lg_u32 s60, 0
  s_cbranch_scc1 NOHALO0
  s_mov_b32 m0, 131584
  s_nop 0
  buffer_load_dwordx4 v22, s[32:35], s77 offen lds
NOHALO0:
  s_add_u32 m0, s76, 132624
  s_nop 0
  buffer_load_dwordx4 v20, s[32:35], s75 offen lds
  buffer_load_dwordx4 v21, s[32:35], s75 offen offset:1040 lds
  s_cmp_lg_u32 s60, 1
  s_cbranch_scc1 NOHALO1
  s_mov_b32 m0, 140944
  s_nop 0
  buffer_load_dwordx4 v22, s[36:39], s77 offen lds
NOHALO1:
  s_add_u32 m0, s76, 141984
  s_nop 0
  buffer_load_dwordx4 v20, s[36:39], s75 offen lds
  buffer_load_dwordx4 v21, s[36:39], s75 offen offset:1040 lds
  s_load_dword s100, s[26:27], 0
  s_branch HSKIP
HELPER:
  s_cmp_ge_u32 s2, 256
  s_cbranch_scc1 END
  s_sub_u32 s2, s2, 224
  v_lshrrev_b32 v3, 6, v0
  v_and_b32 v4, 63, v0
  s_and_b32 s61, s2, 7
  v_readfirstlane_b32 s60, v3
  s_lshr_b32 s62, s2, 3
  s_lshr_b32 s63, s61, 1
  s_and_b32 s64, s61, 1
  s_lshl_b32 s65, s63, 2
  s_add_u32 s65, s65, s62
  s_lshl_b32 s66, s65, 1
  s_add_u32 s66, s66, s64
  v_lshrrev_b32 v5, 3, v4
  v_and_b32 v6, 7, v4
  v_mul_u32_u24 v7, 896, v5
  v_lshl_add_u32 v7, v6, 4, v7
  v_add_u32 v8, 7168, v7
  s_lshl_b32 s67, s66, 2
  s_add_u32 s67, s67, s60
  s_mul_i32 s67, s67, 14336
  s_min_u32 s68, s65, 13
  s_mul_i32 s69, s64, 14
  s_add_u32 s72, s68, s69
  s_lshl_b32 s68, s72, 7
  s_mul_i32 s69, s60, 57344
  s_add_u32 s68, s68, s69
  v_mul_u32_u24 v9, 3584, v5
  v_lshl_add_u32 v9, v6, 4, v9
  v_add_u32 v24, 28672, v9
  s_mov_b32 s30, 1835008
  s_mov_b32 s31, 0x20000
  s_mov_b32 s42, 1605632
  s_mov_b32 s43, 0x20000
  s_mov_b32 s46, 1605632
  s_mov_b32 s47, 0x20000
  s_mov_b32 s54, 19398656
  s_mov_b32 s55, 0x20000
  s_waitcnt lgkmcnt(0)
  s_mov_b64 s[28:29], s[4:5]
  s_mov_b64 s[40:41], s[18:19]
  s_mov_b64 s[44:45], s[20:21]
  s_mov_b64 s[52:53], s[26:27]
  s_load_dword s100, s[26:27], 0
  s_mov_b64 s[48:49], s[12:13]
  s_mov_b32 s50, 1835008
  s_mov_b32 s51, 0x20000
  s_mov_b64 s[32:33], s[6:7]
  s_mov_b32 s34, 1835008
  s_mov_b32 s35, 0x20000
  s_mov_b64 s[36:37], s[8:9]
  s_mov_b32 s38, 1835008
  s_mov_b32 s39, 0x20000
  s_lshl_b32 s69, s2, 13
  s_add_u32 s69, s69, 4096
  v_lshlrev_b32 v11, 5, v0
  v_and_b32 v11, 0x1f80, v11
  v_and_b32 v12, 3, v0
  v_cmp_eq_u32 vcc, 0, v12
  s_nop 0
  s_and_saveexec_b64 s[70:71], vcc
  buffer_load_dword v15, v11, s[52:55], s69 offen
  s_mov_b64 exec, s[70:71]
  v_mov_b32 v14, 0x3f803f80
  v_mov_b32 v16, 0
  v_mov_b32 v17, 0
  v_mov_b32 v18, 0
  v_mov_b32 v19, 0
  v_mov_b32 v150, 0
  v_mov_b32 v151, 0
  v_mov_b32 v152, 0
  v_mov_b32 v153, 0
  v_mov_b32 v154, 0
  v_mov_b32 v155, 0
  v_mov_b32 v156, 0
  v_mov_b32 v157, 0
  s_add_u32 s73, s68, 0
  buffer_load_dwordx4 v[32:35], v7, s[28:31], s67 offen offset:0
  buffer_load_dwordx4 v[40:43], v9, s[40:43], s73 offen
  buffer_load_dwordx4 v[36:39], v8, s[28:31], s67 offen offset:0
  buffer_load_dwordx4 v[44:47], v24, s[40:43], s73 offen
  s_add_u32 s73, s68, 229376
  buffer_load_dwordx4 v[48:51], v7, s[28:31], s67 offen offset:128
  buffer_load_dwordx4 v[56:59], v9, s[40:43], s73 offen
  buffer_load_dwordx4 v[52:55], v8, s[28:31], s67 offen offset:128
  buffer_load_dwordx4 v[60:63], v24, s[40:43], s73 offen
  s_add_u32 s73, s68, 458752
  buffer_load_dwordx4 v[64:67], v7, s[28:31], s67 offen offset:256
  buffer_load_dwordx4 v[72:75], v9, s[40:43], s73 offen
  buffer_load_dwordx4 v[68:71], v8, s[28:31], s67 offen offset:256
  buffer_load_dwordx4 v[76:79], v24, s[40:43], s73 offen
  s_add_u32 s73, s68, 688128
  buffer_load_dwordx4 v[80:83], v7, s[28:31], s67 offen offset:384
  buffer_load_dwordx4 v[88:91], v9, s[40:43], s73 offen
  buffer_load_dwordx4 v[84:87], v8, s[28:31], s67 offen offset:384
  buffer_load_dwordx4 v[92:95], v24, s[40:43], s73 offen
  s_branch HCONT
HSKIP:
  s_lshl_b32 s3, s62, 5
  s_add_u32 s3, s3, s61
  s_lshl_b32 s3, s3, 2
  s_load_dword s98, s[14:15], s3
  s_mov_b64 s[44:45], s[20:21]
  s_mov_b32 s46, 1605632
  s_mov_b32 s47, 0x20000
  s_mov_b64 s[52:53], s[26:27]
  s_mov_b32 s54, 19398656
  s_mov_b32 s55, 0x20000
  s_mov_b64 s[56:57], s[22:23]
  s_mov_b32 s58, 1835008
  s_mov_b32 s59, 0x20000
  s_and_b32 s3, s73, 0xfffff000
  s_add_u32 s3, s3, 2048
  s_load_dwordx2 s[92:93], s[48:49], s3
  s_add_u32 s3, s3, 8
  s_load_dword s97, s[48:49], s3
  v_lshrrev_b32 v9, 5, v0
  v_and_b32 v1, 15, v0
  s_lshr_b32 s71, s60, 1
  s_lshl_b32 s70, s71, 13
  v_lshl_add_u32 v1, v1, 7, s70
  v_bfe_u32 v2, v0, 1, 3
  v_xor_b32 v2, v2, v8
  v_lshl_add_u32 v25, v2, 4, v1
  v_xor_b32 v26, 64, v25
  v_add_u32 v27, 0x10000, v25
  v_add_u32 v28, 0x10000, v26
  v_bfe_u32 v112, v0, 2, 2
  v_and_b32 v1, 3, v0
  v_lshlrev_b32 v113, 3, v1
  v_and_b32 v1, 16, v0
  v_lshl_add_u32 v113, v1, 1, v113
  v_lshl_add_u32 v1, v8, 3, v112
  v_lshl_add_u32 v1, v1, 8, v113
  v_add_u32 v1, 16384, v1
  s_and_b32 s70, s60, 1
  s_lshl_b32 s3, s70, 1
  v_xor_b32 v2, s3, v112
  v_lshl_add_u32 v29, v2, 6, v1
  v_xor_b32 v30, 32, v29
  v_xor_b32 v31, 64, v29
  v_xor_b32 v32, 96, v29
  v_add_u32 v33, 0x10000, v29
  v_add_u32 v34, 0x10000, v30
  v_add_u32 v35, 0x10000, v31
  v_add_u32 v36, 0x10000, v32
  v_mov_b32 v40, 0
  v_mov_b32 v41, 0
  v_mov_b32 v42, 0
  v_mov_b32 v43, 0
  s_lshl_b32 s78, s94, 1
  s_add_u32 s78, s78, s71
  s_lshl_b32 s78, s78, 10
  s_add_u32 s78, s78, 360448
  s_mul_i32 s79, s95, 7
  s_add_u32 s79, s79, s62
  s_lshl_b32 s79, s79, 1
  s_add_u32 s79, s79, s70
  s_lshl_b32 s79, s79, 10
  s_add_u32 s79, s79, 393216
  v_mul_u32_u24 v1, 1040, v7
  v_lshl_add_u32 v37, v11, 2, v1
  v_add_u32 v37, 131584, v37
  v_add_u32 v38, 1040, v37
  v_mul_u32_u24 v1, 12288, v11
  v_lshl_add_u32 v39, v7, 4, v1
  s_mul_i32 s80, s62, 393216
  s_mul_i32 s70, s61, 384
  s_add_u32 s80, s80, s70
  s_add_u32 s80, s80, 1048576
  s_lshr_b32 s70, s61, 3
  s_lshl_b32 s71, s62, 2
  s_add_u32 s81, s71, s70
  s_lshl_b32 s81, s81, 2
  s_add_u32 s81, s81, s60
  s_lshl_b32 s81, s81, 5
  s_and_b32 s72, s61, 7
  s_add_u32 s81, s81, s72
  s_lshl_b32 s81, s81, 2
  s_add_u32 s81, s81, 4096
  s_sub_u32 s72, 3, s60
  s_add_u32 s82, s71, s72
  s_lshl_b32 s82, s82, 2
  s_add_u32 s82, s82, s70
  s_lshl_b32 s82, s82, 7
  s_add_u32 s82, s82, 4096
  s_lshl_b32 s85, s61, 9
  s_add_u32 s85, s85, 36864
  s_mul_i32 s88, s61, 229376
  s_add_u32 s88, s88, 6553600
  s_lshr_b32 s70, s60, 1
  s_and_b32 s71, s60, 1
  s_lshl_b32 s72, s62, 1
  s_add_u32 s72, s72, s71
  s_mul_i32 s86, s70, 114688
  s_add_u32 s86, s86, s88
  s_lshl_b32 s3, s72, 12
  s_add_u32 s86, s86, s3
  v_and_b32 v1, 15, v0
  v_lshlrev_b32 v1, 4, v1
  v_lshl_add_u32 v44, v8, 9, v1
  v_add_u32 v45, 57344, v44
  s_lshl_b32 s3, s72, 1
  s_add_u32 s3, s3, 0
  s_mul_i32 s3, s3, 37
  s_lshr_b32 s3, s3, 8
  s_lshl_b32 s83, s3, 7
  s_add_u32 s83, s83, s85
  s_mul_i32 s3, s3, 7
  s_lshr_b32 s3, s3, 1
  s_sub_u32 s3, s72, s3
  s_lshl_b32 s3, s3, 1
  s_add_u32 s3, s3, s70
  s_lshl_b32 s3, s3, 2
  s_add_u32 s83, s83, s3
  s_lshl_b32 s3, s72, 1
  s_add_u32 s3, s3, 1
  s_mul_i32 s3, s3, 37
  s_lshr_b32 s3, s3, 8
  s_lshl_b32 s84, s3, 7
  s_add_u32 s84, s84, s85
  s_mul_i32 s3, s3, 7
  s_lshr_b32 s3, s3, 1
  s_sub_u32 s3, s72, s3
  s_lshl_b32 s3, s3, 1
  s_add_u32 s3, s3, s70
  s_lshl_b32 s3, s3, 2
  s_add_u32 s84, s84, s3
  s_lshl_b32 s3, s60, 7
  s_add_u32 s85, s85, s3
  s_mul_i32 s3, s60, 14336
  s_add_u32 s88, s88, s3
  s_mul_i32 s3, s95, 114688
  s_sub_u32 s87, s88, s3
  s_add_u32 s87, s87, 114688
  s_add_u32 s88, s88, s3
  v_and_b32 v2, 16, v0
  v_lshlrev_b32 v2, 2, v2
  v_xor_b32 v46, v2, v20
  v_add_u32 v47, 6144, v46
  v_add_u32 v48, 12288, v46
  v_add_u32 v49, 18432, v46
  s_lshl_b32 s89, s95, 2
  s_add_u32 s89, s89, s60
  s_mul_i32 s89, s89, 200704
  s_lshl_b32 s72, s62, 7
  s_add_u32 s89, s89, s72
  v_lshl_add_u32 v1, v9, 2, v112
  v_lshl_add_u32 v1, v1, 7, v113
  v_add_u32 v1, s67, v1
  v_lshrrev_b32 v2, 1, v112
  v_lshl_add_u32 v50, v2, 6, v1
  v_xor_b32 v51, 64, v50
  v_add_u32 v52, 0x10000, v50
  v_add_u32 v53, 0x10000, v51
  s_lshl_b32 s96, s62, 5
  s_add_u32 s96, s96, s61
  s_lshl_b32 s96, s96, 13
  s_mul_i32 s72, s70, 16640
  s_add_u32 s72, s72, 98304
  s_lshl_b32 s3, s71, 11
  s_add_u32 s3, s3, s72
  v_add_u32 v61, s3, v10
  v_and_b32 v1, 15, v0
  v_mul_u32_u24 v2, 1040, v8
  v_add_lshl_u32 v54, v1, v2, 2
  v_add_u32 v54, s72, v54
  s_lshl_b32 s3, s71, 6
  v_add3_u32 v55, v1, v8, s3
  v_mov_b32 v2, 152064
  v_cmp_ge_u32 vcc, 17, v55
  s_nop 1
  v_cndmask_b32 v54, v2, v54, vcc
  v_and_b32 v1, 3, v0
  v_mul_u32_u24 v1, 4160, v1
  v_add_u32 v2, v112, v8
  v_lshl_add_u32 v1, v2, 4, v1
  s_lshl_b32 s3, s71, 8
  s_add_u32 s72, s72, s3
  v_add_u32 v56, s72, v1
  v_and_b32 v1, 1, v0
  v_mul_u32_u24 v1, 4576, v1
  v_bfe_u32 v2, v0, 1, 3
  v_lshlrev_b32 v2, 2, v2
  v_sub_u32 v2, v8, v2
  v_lshl_add_u32 v1, v2, 4, v1
  s_mul_i32 s72, s70, 9152
  s_add_u32 s72, s72, s3
  s_add_u32 s72, s72, 132032
  v_add_u32 v57, s72, v1
  s_lshr_b32 s91, s96, 13
  s_mul_i32 s91, s91, 12288
  s_add_u32 s91, s91, 1048576
  s_lshl_b32 s3, s60, 10
  s_add_u32 s3, s3, 131584
  v_add_u32 v58, s3, v10
  v_min_u32 v1, 29, v0
  s_mul_i32 s3, s60, 4576
  s_add_u32 s3, s3, 135680
  v_lshl_add_u32 v59, v1, 4, s3
  v_sub_u32 v1, 31, v11
  v_mul_u32_u24 v1, 384, v1
  v_sub_u32 v2, 7, v7
  v_lshl_add_u32 v60, v2, 4, v1
  v_mul_u32_u24 v1, 896, v11
  v_lshl_add_u32 v62, v7, 4, v1
  v_lshlrev_b32 v23, 4, v11
  v_add_u32 v23, 151040, v23
  s_lshl_b32 s3, s95, 6
  v_add_u32 v1, s3, v11
  v_lshlrev_b32 v63, 2, v1
  v_add_u32 v63, 152320, v63
  v_bfe_u32 v2, v1, 1, 3
  v_xor_b32 v2, v2, v7
  v_lshlrev_b32 v1, 7, v1
  v_lshl_add_u32 v68, v2, 4, v1
  s_lshl_b32 s3, s70, 8
  s_add_u32 s3, s3, 152320
  v_lshl_add_u32 v69, v0, 2, s3
  s_mul_i32 s90, s61, 57344
  s_lshl_b32 s3, s62, 7
  s_add_u32 s90, s90, s3
  v_and_b32 v1, 15, v0
  v_lshl_add_u32 v1, v8, 2, v1
  s_waitcnt lgkmcnt(0)
  s_lshl_b32 s3, s70, 4
  s_lshr_b32 s98, s98, s3
  s_and_b32 s98, s98, 0xffff
  s_cmp_eq_u32 s71, 0
  s_cselect_b32 s98, s98, 0
  v_mov_b32 v2, s98
  v_cmp_eq_u32 vcc, 15, v1
  s_nop 1
  v_cndmask_b32 v64, 0, v2, vcc
  v_cmp_eq_u32 vcc, 14, v1
  s_nop 1
  v_cndmask_b32 v65, 0, v2, vcc
  v_cmp_eq_u32 vcc, 13, v1
  s_nop 1
  v_cndmask_b32 v66, 0, v2, vcc
  v_cmp_eq_u32 vcc, 12, v1
  s_nop 1
  v_cndmask_b32 v67, 0, v2, vcc
  s_mul_i32 s100, s100, 2654435761
  s_add_u32 s100, s100, 2135587861
  s_and_b32 s100, s100, 3221209087
  s_mov_b32 s101, s100
  s_mov_b32 m0, s66
  s_nop 0
  buffer_load_dwordx4 v12, s[28:31], s63 offen offset:0 lds
  buffer_load_dwordx4 v13, s[28:31], s63 offen offset:1024 lds
  s_waitcnt vmcnt(6)
  v_readfirstlane_b32 s3, v240
  v_readfirstlane_b32 s70, v241
  v_readfirstlane_b32 s71, v242
  v_cmp_eq_u32 vcc, 15, v55
  v_mov_b32 v168, s3
  v_mov_b32 v169, s70
  v_mov_b32 v170, s71
  v_cndmask_b32 v70, 0, v168, vcc
  v_cmp_eq_u32 vcc, 16, v55
  s_nop 1
  v_cndmask_b32 v70, v70, v169, vcc
  v_cmp_eq_u32 vcc, 17, v55
  s_nop 1
  v_cndmask_b32 v70, v70, v170, vcc
  ds_write_b32 v54, v70
  v_readfirstlane_b32 s3, v248
  v_readfirstlane_b32 s70, v249
  v_readfirstlane_b32 s71, v250
  v_mov_b32 v252, s92
  v_mov_b32 v253, s93
  v_mov_b32 v254, s97
  v_mov_b32 v244, s3
  v_mov_b32 v245, s70
  v_mov_b32 v246, s71
  v_mov_b32_dpp v244, v240 wave_shl:1 row_mask:0xf bank_mask:0xf
  v_mov_b32_dpp v245, v241 wave_shl:1 row_mask:0xf bank_mask:0xf
  v_mov_b32_dpp v246, v242 wave_shl:1 row_mask:0xf bank_mask:0xf
  v_mov_b32_dpp v252, v248 wave_shl:1 row_mask:0xf bank_mask:0xf
  v_mov_b32_dpp v253, v249 wave_shl:1 row_mask:0xf bank_mask:0xf
  v_mov_b32_dpp v254, v250 wave_shl:1 row_mask:0xf bank_mask:0xf
  ds_write_b128 v61, v[240:243] offset:12528
  buffer_load_dwordx4 v14, s[28:31], s63 offen offset:2048 lds
  ds_write_b128 v61, v[242:245] offset:4224
  buffer_load_dwordx4 v15, s[28:31], s63 offen offset:3072 lds
  v_mov_b32 v168, v241
  v_mov_b32 v169, v242
  v_mov_b32 v170, v243
  v_mov_b32 v171, v244
  v_mov_b32 v172, v245
  v_mov_b32 v173, v246
  ds_write_b128 v61, v[168:171] offset:64
  s_add_u32 m0, s66, 16384
  s_nop 0
  buffer_load_dwordx4 v16, s[40:43], s64 offen offset:0 lds
  ds_write_b128 v61, v[170:173] offset:8384
  buffer_load_dwordx4 v17, s[40:43], s64 offen offset:1024 lds
  ds_write_b128 v61, v[248:251] offset:13552
  buffer_load_dwordx4 v18, s[40:43], s64 offen offset:2048 lds
  ds_write_b128 v61, v[250:253] offset:5248
  buffer_load_dwordx4 v19, s[40:43], s64 offen offset:3072 lds
  v_mov_b32 v168, v249
  v_mov_b32 v169, v250
  v_mov_b32 v170, v251
  v_mov_b32 v171, v252
  v_mov_b32 v172, v253
  v_mov_b32 v173, v254
  ds_write_b128 v61, v[168:171] offset:1088
  s_add_u32 s65, s65, 1
  s_cmp_eq_u32 s65, 7
  s_cselect_b32 s3, 4294966528, s68
  s_add_u32 s63, s63, s3
  s_cmp_eq_u32 s65, 7
  s_cselect_b32 s3, 4293591040, s69
  s_add_u32 s64, s64, s3
  ds_write_b128 v61, v[170:173] offset:9408
  s_mov_b64 exec, 0
  s_branch PG1
PGBACK:
  s_mov_b64 exec, -1
  s_waitcnt vmcnt(8)
  s_barrier
  s_add_u32 m0, s66, 32768
  ds_read_b128 v[72:75], v23
  buffer_load_dwordx4 v12, s[28:31], s63 offen offset:0 lds
  ds_read2_b32 v[136:137], v37 offset0:128 offset1:160
  ds_read2_b32 v[138:139], v37 offset0:192 offset1:224
  ds_read2_b32 v[140:141], v38 offset0:0 offset1:32
  ds_read2_b32 v[142:143], v38 offset0:64 offset1:96
  ds_read2_b32 v[144:145], v38 offset0:128 offset1:160
  ds_read2_b32 v[146:147], v38 offset0:192 offset1:224
  v_add_u32 v38, 9360, v38
  ds_read_b32 v156, v37 offset:10256
  ds_read2_b32 v[148:149], v38 offset0:0 offset1:32
  ds_read2_b32 v[150:151], v38 offset0:64 offset1:96
  ds_read2_b32 v[152:153], v38 offset0:128 offset1:160
  ds_read2_b32 v[154:155], v38 offset0:192 offset1:224
  s_waitcnt lgkmcnt(11)
  v_lshlrev_b32 v158, 16, v72
  v_and_b32 v160, 0xffff0000, v72
  v_lshlrev_b32 v162, 16, v73
  v_and_b32 v164, 0xffff0000, v73
  buffer_load_dwordx4 v13, s[28:31], s63 offen offset:1024 lds
  v_lshlrev_b32 v159, 16, v74
  v_and_b32 v161, 0xffff0000, v74
  v_lshlrev_b32 v163, 16, v75
  v_and_b32 v165, 0xffff0000, v75
  s_waitcnt lgkmcnt(5)
  v_lshlrev_b32 v112, 16, v136
  v_and_b32 v113, 0xffff0000, v136
  v_lshlrev_b32 v114, 16, v137
  v_and_b32 v115, 0xffff0000, v137
  v_lshlrev_b32 v116, 16, v138
  v_and_b32 v117, 0xffff0000, v138
  v_lshlrev_b32 v118, 16, v139
  v_and_b32 v119, 0xffff0000, v139
  v_lshlrev_b32 v120, 16, v140
  v_and_b32 v121, 0xffff0000, v140
  v_lshlrev_b32 v122, 16, v141
  v_and_b32 v123, 0xffff0000, v141
  v_lshlrev_b32 v124, 16, v142
  buffer_load_dwordx4 v14, s[28:31], s63 offen offset:2048 lds
  v_and_b32 v125, 0xffff0000, v142
  v_lshlrev_b32 v126, 16, v143
  v_and_b32 v127, 0xffff0000, v143
  v_lshlrev_b32 v128, 16, v144
  v_and_b32 v129, 0xffff0000, v144
  v_lshlrev_b32 v130, 16, v145
  v_and_b32 v131, 0xffff0000, v145
  v_lshlrev_b32 v132, 16, v146
  v_and_b32 v133, 0xffff0000, v146
  v_lshlrev_b32 v134, 16, v147
  v_and_b32 v135, 0xffff0000, v147
  s_waitcnt lgkmcnt(0)
  v_pk_mul_f32 v[166:167], v[112:113], v[164:165]
  v_pk_mul_f32 v[176:177], v[114:115], v[164:165]
  v_pk_mul_f32 v[178:179], v[116:117], v[164:165]
  v_pk_mul_f32 v[180:181], v[118:119], v[164:165]
  v_pk_mul_f32 v[182:183], v[120:121], v[164:165]
  v_pk_mul_f32 v[184:185], v[122:123], v[164:165]
  v_pk_mul_f32 v[186:187], v[124:125], v[164:165]
  v_pk_mul_f32 v[188:189], v[126:127], v[164:165]
  v_pk_mul_f32 v[190:191], v[128:129], v[164:165]
  v_pk_fma_f32 v[166:167], v[114:115], v[162:163], v[166:167]
  v_pk_fma_f32 v[176:177], v[116:117], v[162:163], v[176:177]
  v_pk_fma_f32 v[178:179], v[118:119], v[162:163], v[178:179]
  v_pk_fma_f32 v[180:181], v[120:121], v[162:163], v[180:181]
  v_pk_fma_f32 v[182:183], v[122:123], v[162:163], v[182:183]
  v_pk_fma_f32 v[184:185], v[124:125], v[162:163], v[184:185]
  v_pk_fma_f32 v[186:187], v[126:127], v[162:163], v[186:187]
  v_pk_fma_f32 v[188:189], v[128:129], v[162:163], v[188:189]
  v_pk_fma_f32 v[190:191], v[130:131], v[162:163], v[190:191]
  v_pk_fma_f32 v[166:167], v[116:117], v[160:161], v[166:167]
  v_pk_fma_f32 v[176:177], v[118:119], v[160:161], v[176:177]
  v_pk_fma_f32 v[178:179], v[120:121], v[160:161], v[178:179]
  v_pk_fma_f32 v[180:181], v[122:123], v[160:161], v[180:181]
  v_pk_fma_f32 v[182:183], v[124:125], v[160:161], v[182:183]
  v_pk_fma_f32 v[184:185], v[126:127], v[160:161], v[184:185]
  v_pk_fma_f32 v[186:187], v[128:129], v[160:161], v[186:187]
  v_pk_fma_f32 v[188:189], v[130:131], v[160:161], v[188:189]
  v_pk_fma_f32 v[190:191], v[132:133], v[160:161], v[190:191]
  v_pk_fma_f32 v[166:167], v[118:119], v[158:159], v[166:167]
  v_pk_fma_f32 v[176:177], v[120:121], v[158:159], v[176:177]
  v_pk_fma_f32 v[178:179], v[122:123], v[158:159], v[178:179]
  v_pk_fma_f32 v[180:181], v[124:125], v[158:159], v[180:181]
  v_pk_fma_f32 v[182:183], v[126:127], v[158:159], v[182:183]
  v_pk_fma_f32 v[184:185], v[128:129], v[158:159], v[184:185]
  v_pk_fma_f32 v[186:187], v[130:131], v[158:159], v[186:187]
  v_pk_fma_f32 v[188:189], v[132:133], v[158:159], v[188:189]
  v_pk_fma_f32 v[190:191], v[134:135], v[158:159], v[190:191]
  v_lshlrev_b32 v112, 16, v156
  v_and_b32 v113, 0xffff0000, v156
  v_pk_mul_f32 v[166:167], v[166:167], v[112:113]
  v_lshlrev_b32 v114, 16, v148
  v_and_b32 v115, 0xffff0000, v148
  v_pk_mul_f32 v[176:177], v[176:177], v[114:115]
  v_lshlrev_b32 v116, 16, v149
  v_and_b32 v117, 0xffff0000, v149
  v_pk_mul_f32 v[178:179], v[178:179], v[116:117]
  v_lshlrev_b32 v118, 16, v150
  v_and_b32 v119, 0xffff0000, v150
  v_pk_mul_f32 v[180:181], v[180:181], v[118:119]
  v_lshlrev_b32 v120, 16, v151
  v_and_b32 v121, 0xffff0000, v151
  v_pk_mul_f32 v[182:183], v[182:183], v[120:121]
  v_lshlrev_b32 v122, 16, v152
  v_and_b32 v123, 0xffff0000, v152
  v_pk_mul_f32 v[184:185], v[184:185], v[122:123]
  v_lshlrev_b32 v124, 16, v153
  v_and_b32 v125, 0xffff0000, v153
  v_pk_mul_f32 v[186:187], v[186:187], v[124:125]
  v_lshlrev_b32 v126, 16, v154
  v_and_b32 v127, 0xffff0000, v154
  v_pk_mul_f32 v[188:189], v[188:189], v[126:127]
  v_lshlrev_b32 v128, 16, v155
  v_and_b32 v129, 0xffff0000, v155
  v_pk_mul_f32 v[190:191], v[190:191], v[128:129]
  v_mov_b32 v139, s100
  v_mov_b32 v143, s100
  v_mov_b32 v147, s100
  v_cvt_pk_bf16_f32 v136, v190, v188
  v_cvt_pk_bf16_f32 v137, v186, v184
  v_cvt_pk_bf16_f32 v138, v182, v180
  v_cvt_pk_bf16_f32 v144, v178, v176
  v_cvt_pk_bf16_f32 v140, v191, v189
  v_cvt_pk_bf16_f32 v141, v187, v185
  v_cvt_pk_bf16_f32 v142, v183, v181
  v_cvt_pk_bf16_f32 v145, v179, v177
  v_cvt_pk_bf16_f32 v146, v166, v167
  buffer_load_dwordx4 v15, s[28:31], s63 offen offset:3072 lds
  s_add_u32 m0, s66, 49152
  s_nop 0
  buffer_load_dwordx4 v16, s[40:43], s64 offen offset:0 lds
PG1:
  s_cbranch_execz PG2
  buffer_load_dwordx4 v17, s[40:43], s64 offen offset:1024 lds
  buffer_load_dwordx4 v18, s[40:43], s64 offen offset:2048 lds
  buffer_load_dwordx4 v19, s[40:43], s64 offen offset:3072 lds
  s_add_u32 s65, s65, 1
  s_cmp_eq_u32 s65, 7
  s_cselect_b32 s3, 4294966528, s68
  s_add_u32 s63, s63, s3
  s_cmp_eq_u32 s65, 7
  s_cselect_b32 s3, 4293591040, s69
  s_add_u32 s64, s64, s3
  s_waitcnt vmcnt(8)
  s_add_u32 m0, s66, 65536
  s_nop 0
  buffer_load_dwordx4 v12, s[28:31], s63 offen offset:0 lds
  buffer_load_dwordx4 v13, s[28:31], s63 offen offset:1024 lds
  buffer_load_dwordx4 v14, s[28:31], s63 offen offset:2048 lds
  buffer_load_dwordx4 v15, s[28:31], s63 offen offset:3072 lds
  s_barrier
  ds_read_b64_tr_b16 a[176:177], v29 offset:0
  ds_read_b64_tr_b16 a[178:179], v29 offset:1024
  ds_read_b128 a[160:163], v25 offset:0
  ds_read_b128 a[164:167], v25 offset:2048
  ds_read_b128 a[168:171], v25 offset:4096
  ds_read_b128 a[172:175], v25 offset:6144
  ds_read_b64_tr_b16 a[180:181], v30 offset:0
  ds_read_b64_tr_b16 a[182:183], v30 offset:1024
  ds_read_b64_tr_b16 a[184:185], v31 offset:0
  ds_read_b64_tr_b16 a[186:187], v31 offset:1024
  ds_read_b64_tr_b16 a[188:189], v32 offset:0
  ds_read_b64_tr_b16 a[190:191], v32 offset:1024
  s_waitcnt lgkmcnt(4)
  s_add_u32 m0, s66, 81920
  s_nop 0
  buffer_load_dwordx4 v16, s[40:43], s64 offen offset:0 lds
  v_mfma_f32_16x16x32_bf16 v[176:179], a[176:179], a[160:163], 0
  s_cmp_eq_u32 s74, 0
  s_cbranch_scc1 DOX0
NOX0:
  ds_read_b64_tr_b16 a[208:209], v29 offset:8192
  v_mfma_f32_16x16x32_bf16 v[184:187], a[176:179], a[164:167], 0
  ds_read_b64_tr_b16 a[210:211], v29 offset:9216
  v_mfma_f32_16x16x32_bf16 v[192:195], a[176:179], a[168:171], 0
  ds_read_b128 a[192:195], v26 offset:0
  v_mfma_f32_16x16x32_bf16 v[200:203], a[176:179], a[172:175], 0
  buffer_load_dwordx4 v17, s[40:43], s64 offen offset:1024 lds
  ds_read_b128 a[196:199], v26 offset:2048
  v_mfma_f32_16x16x32_bf16 v[204:207], a[180:183], a[172:175], 0
  ds_read_b128 a[200:203], v26 offset:4096
  v_mfma_f32_16x16x32_bf16 v[196:199], a[180:183], a[168:171], 0
  ds_read_b128 a[204:207], v26 offset:6144
  v_mfma_f32_16x16x32_bf16 v[188:191], a[180:183], a[164:167], 0
  v_mfma_f32_16x16x32_bf16 v[180:183], a[180:183], a[160:163], 0
  buffer_load_dwordx4 v18, s[40:43], s64 offen offset:2048 lds
  s_waitcnt lgkmcnt(6)
  v_mfma_f32_16x16x32_bf16 v[208:211], a[184:187], a[160:163], 0
  ds_read_b64_tr_b16 a[212:213], v30 offset:8192
  v_mfma_f32_16x16x32_bf16 v[216:219], a[184:187], a[164:167], 0
  ds_read_b64_tr_b16 a[214:215], v30 offset:9216
  v_mfma_f32_16x16x32_bf16 v[224:227], a[184:187], a[168:171], 0
  ds_read_b64_tr_b16 a[216:217], v31 offset:8192
  v_mfma_f32_16x16x32_bf16 v[232:235], a[184:187], a[172:175], 0
  buffer_load_dwordx4 v19, s[40:43], s64 offen offset:3072 lds
  s_add_u32 s65, s65, 1
  s_cmp_eq_u32 s65, 7
  s_cselect_b32 s3, 4294966528, s68
  s_add_u32 s63, s63, s3
  s_cmp_eq_u32 s65, 7
  s_cselect_b32 s3, 4293591040, s69
  s_add_u32 s64, s64, s3
  ds_read_b64_tr_b16 a[218:219], v31 offset:9216
  v_mfma_f32_16x16x32_bf16 v[236:239], a[188:191], a[172:175], 0
  ds_read_b64_tr_b16 a[220:221], v32 offset:8192
  v_mfma_f32_16x16x32_bf16 v[228:231], a[188:191], a[168:171], 0
  ds_read_b64_tr_b16 a[222:223], v32 offset:9216
  v_mfma_f32_16x16x32_bf16 v[220:223], a[188:191], a[164:167], 0
  buffer_store_dwordx4 v[136:139], v39, s[52:55], s80 offen offset:0 sc1
  v_mfma_f32_16x16x32_bf16 v[212:215], a[188:191], a[160:163], 0
  s_waitcnt lgkmcnt(4)
  v_mfma_f32_16x16x32_bf16 v[176:179], a[208:211], a[192:195], v[176:179]
  v_mfma_f32_16x16x32_bf16 v[184:187], a[208:211], a[196:199], v[184:187]
  v_mfma_f32_16x16x32_bf16 v[192:195], a[208:211], a[200:203], v[192:195]
  buffer_store_dwordx4 v[140:143], v39, s[52:55], s80 offen offset:128 sc1
  s_waitcnt vmcnt(10) lgkmcnt(0)
  s_barrier
  ds_read_b64_tr_b16 a[176:177], v29 offset:32768
  v_mfma_f32_16x16x32_bf16 v[200:203], a[208:211], a[204:207], v[200:203]
  ds_read_b64_tr_b16 a[178:179], v29 offset:33792
  v_mfma_f32_16x16x32_bf16 v[204:207], a[212:215], a[204:207], v[204:207]
  buffer_store_dwordx4 v[144:147], v39, s[52:55], s80 offen offset:256 sc1
  ds_read_b128 a[160:163], v25 offset:32768
  v_mfma_f32_16x16x32_bf16 v[196:199], a[212:215], a[200:203], v[196:199]
  ds_read_b128 a[164:167], v25 offset:34816
  v_mfma_f32_16x16x32_bf16 v[188:191], a[212:215], a[196:199], v[188:191]
  ds_read_b128 a[168:171], v25 offset:36864
  v_mfma_f32_16x16x32_bf16 v[180:183], a[212:215], a[192:195], v[180:183]
  ds_read_b128 a[172:175], v25 offset:38912
  s_mov_b32 m0, s66
  v_mfma_f32_16x16x32_bf16 v[208:211], a[216:219], a[192:195], v[208:211]
  buffer_load_dwordx4 v12, s[28:31], s63 offen offset:0 lds
  ds_read_b64_tr_b16 a[180:181], v30 offset:32768
  v_mfma_f32_16x16x32_bf16 v[216:219], a[216:219], a[196:199], v[216:219]
  ds_read_b64_tr_b16 a[182:183], v30 offset:33792
  v_mfma_f32_16x16x32_bf16 v[224:227], a[216:219], a[200:203], v[224:227]
  ds_read_b64_tr_b16 a[184:185], v31 offset:32768
  v_mfma_f32_16x16x32_bf16 v[232:235], a[216:219], a[204:207], v[232:235]
  ds_read_b64_tr_b16 a[186:187], v31 offset:33792
  v_mfma_f32_16x16x32_bf16 v[236:239], a[220:223], a[204:207], v[236:239]
  buffer_load_dwordx4 v13, s[28:31], s63 offen offset:1024 lds
  ds_read_b64_tr_b16 a[188:189], v32 offset:32768
  v_mfma_f32_16x16x32_bf16 v[228:231], a[220:223], a[200:203], v[228:231]
  ds_read_b64_tr_b16 a[190:191], v32 offset:33792
  v_mfma_f32_16x16x32_bf16 v[220:223], a[220:223], a[196:199], v[220:223]
  v_mfma_f32_16x16x32_bf16 v[212:215], a[220:223], a[192:195], v[212:215]
  s_waitcnt lgkmcnt(4)
  v_mfma_f32_16x16x32_bf16 v[176:179], a[176:179], a[160:163], v[176:179]
  buffer_load_dwordx4 v14, s[28:31], s63 offen offset:2048 lds
  s_cmp_eq_u32 s74, 1
  s_cbranch_scc1 DOX1
NOX1:
  ds_read_b64_tr_b16 a[208:209], v29 offset:40960
  v_mfma_f32_16x16x32_bf16 v[184:187], a[176:179], a[164:167], v[184:187]
  ds_read_b64_tr_b16 a[210:211], v29 offset:41984
  v_mfma_f32_16x16x32_bf16 v[192:195], a[176:179], a[168:171], v[192:195]
  ds_read_b128 a[192:195], v26 offset:32768
  v_mfma_f32_16x16x32_bf16 v[200:203], a[176:179], a[172:175], v[200:203]
  ds_read_b128 a[196:199], v26 offset:34816
  v_mfma_f32_16x16x32_bf16 v[204:207], a[180:183], a[172:175], v[204:207]
  buffer_load_dwordx4 v15, s[28:31], s63 offen offset:3072 lds
  ds_read_b128 a[200:203], v26 offset:36864
  v_mfma_f32_16x16x32_bf16 v[196:199], a[180:183], a[168:171], v[196:199]
  ds_read_b128 a[204:207], v26 offset:38912
  v_mfma_f32_16x16x32_bf16 v[188:191], a[180:183], a[164:167], v[188:191]
  v_mfma_f32_16x16x32_bf16 v[180:183], a[180:183], a[160:163], v[180:183]
  s_waitcnt lgkmcnt(6)
  s_add_u32 m0, s66, 16384
  v_mfma_f32_16x16x32_bf16 v[208:211], a[184:187], a[160:163], v[208:211]
  buffer_load_dwordx4 v16, s[40:43], s64 offen offset:0 lds
  ds_read_b64_tr_b16 a[212:213], v30 offset:40960
  v_mfma_f32_16x16x32_bf16 v[216:219], a[184:187], a[164:167], v[216:219]
  ds_read_b64_tr_b16 a[214:215], v30 offset:41984
  v_mfma_f32_16x16x32_bf16 v[224:227], a[184:187], a[168:171], v[224:227]
  ds_read_b64_tr_b16 a[216:217], v31 offset:40960
  v_mfma_f32_16x16x32_bf16 v[232:235], a[184:187], a[172:175], v[232:235]
  ds_read_b64_tr_b16 a[218:219], v31 offset:41984
  v_mfma_f32_16x16x32_bf16 v[236:239], a[188:191], a[172:175], v[236:239]
  buffer_load_dwordx4 v17, s[40:43], s64 offen offset:1024 lds
  ds_read_b64_tr_b16 a[220:221], v32 offset:40960
  v_mfma_f32_16x16x32_bf16 v[228:231], a[188:191], a[168:171], v[228:231]
  ds_read_b64_tr_b16 a[222:223], v32 offset:41984
  v_mfma_f32_16x16x32_bf16 v[220:223], a[188:191], a[164:167], v[220:223]
  v_mfma_f32_16x16x32_bf16 v[212:215], a[188:191], a[160:163], v[212:215]
  s_atomic_swap s100, s[26:27], s81
  s_waitcnt lgkmcnt(4)
  buffer_load_dwordx4 v18, s[40:43], s64 offen offset:2048 lds
  v_mfma_f32_16x16x32_bf16 v[176:179], a[208:211], a[192:195], v[176:179]
  v_mfma_f32_16x16x32_bf16 v[184:187], a[208:211], a[196:199], v[184:187]
  v_mfma_f32_16x16x32_bf16 v[192:195], a[208:211], a[200:203], v[192:195]
  ds_read_b32 v5, v40
  s_waitcnt vmcnt(10) lgkmcnt(1)
  s_barrier
  buffer_load_dwordx4 v19, s[40:43], s64 offen offset:3072 lds
  ds_read_b64_tr_b16 a[176:177], v33 offset:0
  s_add_u32 s65, s65, 1
  s_cmp_eq_u32 s65, 7
  s_cselect_b32 s3, 4294966528, s68
  s_add_u32 s63, s63, s3
  s_cmp_eq_u32 s65, 7
  s_cselect_b32 s3, 4293591040, s69
  s_add_u32 s64, s64, s3
  v_mfma_f32_16x16x32_bf16 v[200:203], a[208:211], a[204:207], v[200:203]
  ds_read_b64_tr_b16 a[178:179], v33 offset:1024
  s_add_u32 m0, s66, 32768
  v_mfma_f32_16x16x32_bf16 v[204:207], a[212:215], a[204:207], v[204:207]
  buffer_load_dwordx4 v12, s[28:31], s63 offen offset:0 lds
  ds_read_b128 a[160:163], v27 offset:0
  v_mfma_f32_16x16x32_bf16 v[196:199], a[212:215], a[200:203], v[196:199]
  ds_read_b128 a[164:167], v27 offset:2048
  v_mfma_f32_16x16x32_bf16 v[188:191], a[212:215], a[196:199], v[188:191]
  ds_read_b128 a[168:171], v27 offset:4096
  v_mfma_f32_16x16x32_bf16 v[180:183], a[212:215], a[192:195], v[180:183]
  ds_read_b128 a[172:175], v27 offset:6144
  v_mfma_f32_16x16x32_bf16 v[208:211], a[216:219], a[192:195], v[208:211]
  buffer_load_dwordx4 v13, s[28:31], s63 offen offset:1024 lds
  ds_read_b64_tr_b16 a[180:181], v34 offset:0
  v_mfma_f32_16x16x32_bf16 v[216:219], a[216:219], a[196:199], v[216:219]
  ds_read_b64_tr_b16 a[182:183], v34 offset:1024
  v_mfma_f32_16x16x32_bf16 v[224:227], a[216:219], a[200:203], v[224:227]
  ds_read_b64_tr_b16 a[184:185], v35 offset:0
  v_mfma_f32_16x16x32_bf16 v[232:235], a[216:219], a[204:207], v[232:235]
  ds_read_b64_tr_b16 a[186:187], v35 offset:1024
  v_mfma_f32_16x16x32_bf16 v[236:239], a[220:223], a[204:207], v[236:239]
  buffer_load_dwordx4 v14, s[28:31], s63 offen offset:2048 lds
  ds_read_b64_tr_b16 a[188:189], v36 offset:0
  v_mfma_f32_16x16x32_bf16 v[228:231], a[220:223], a[200:203], v[228:231]
  ds_read_b64_tr_b16 a[190:191], v36 offset:1024
  v_mfma_f32_16x16x32_bf16 v[220:223], a[220:223], a[196:199], v[220:223]
  v_mfma_f32_16x16x32_bf16 v[212:215], a[220:223], a[192:195], v[212:215]
  s_waitcnt lgkmcnt(4)
  v_mfma_f32_16x16x32_bf16 v[176:179], a[176:179], a[160:163], v[176:179]
  buffer_load_dwordx4 v15, s[28:31], s63 offen offset:3072 lds
  v_and_b32 v1, 15, v0
  s_cmp_eq_u32 s74, 2
  s_cbranch_scc1 DOX2
NOX2:
  ds_read_b64_tr_b16 a[208:209], v33 offset:8192
  v_mfma_f32_16x16x32_bf16 v[184:187], a[176:179], a[164:167], v[184:187]
  v_lshlrev_b32 v2, 2, v8
  ds_read_b64_tr_b16 a[210:211], v33 offset:9216
  v_mfma_f32_16x16x32_bf16 v[192:195], a[176:179], a[168:171], v[192:195]
  ds_read_b128 a[192:195], v28 offset:0
  s_add_u32 m0, s66, 49152
  v_mfma_f32_16x16x32_bf16 v[200:203], a[176:179], a[172:175], v[200:203]
  buffer_load_dwordx4 v16, s[40:43], s64 offen offset:0 lds
  v_xor_b32 v1, v1, v2
  ds_read_b128 a[196:199], v28 offset:2048
  v_mfma_f32_16x16x32_bf16 v[204:207], a[180:183], a[172:175], v[204:207]
  ds_read_b128 a[200:203], v28 offset:4096
  v_mfma_f32_16x16x32_bf16 v[196:199], a[180:183], a[168:171], v[196:199]
  v_lshlrev_b32 v1, 4, v1
  ds_read_b128 a[204:207], v28 offset:6144
  v_mfma_f32_16x16x32_bf16 v[188:191], a[180:183], a[164:167], v[188:191]
  v_mfma_f32_16x16x32_bf16 v[180:183], a[180:183], a[160:163], v[180:183]
  buffer_load_dwordx4 v17, s[40:43], s64 offen offset:1024 lds
  v_lshl_add_u32 v1, v8, 8, v1
  s_waitcnt lgkmcnt(6)
  v_mfma_f32_16x16x32_bf16 v[208:211], a[184:187], a[160:163], v[208:211]
  s_add_u32 s70, s67, 32768
  ds_read_b64_tr_b16 a[212:213], v34 offset:8192
  v_mfma_f32_16x16x32_bf16 v[216:219], a[184:187], a[164:167], v[216:219]
  ds_read_b64_tr_b16 a[214:215], v34 offset:9216
  v_mfma_f32_16x16x32_bf16 v[224:227], a[184:187], a[168:171], v[224:227]
  v_add_u32 v86, s70, v1
  ds_read_b64_tr_b16 a[216:217], v35 offset:8192
  v_mfma_f32_16x16x32_bf16 v[232:235], a[184:187], a[172:175], v[232:235]
  buffer_load_dwordx4 v18, s[40:43], s64 offen offset:2048 lds
  ds_read_b64_tr_b16 a[218:219], v35 offset:9216
  v_mfma_f32_16x16x32_bf16 v[236:239], a[188:191], a[172:175], v[236:239]
  v_and_b32 v2, 3, v0
  ds_read_b64_tr_b16 a[220:221], v36 offset:8192
  v_mfma_f32_16x16x32_bf16 v[228:231], a[188:191], a[168:171], v[228:231]
  ds_read_b64_tr_b16 a[222:223], v36 offset:9216
  v_mfma_f32_16x16x32_bf16 v[220:223], a[188:191], a[164:167], v[220:223]
  v_bfe_u32 v3, v0, 2, 3
  v_mfma_f32_16x16x32_bf16 v[212:215], a[188:191], a[160:163], v[212:215]
  buffer_load_dwordx4 v19, s[40:43], s64 offen offset:3072 lds
  s_add_u32 s65, s65, 1
  s_cmp_eq_u32 s65, 7
  s_cselect_b32 s3, 4294966528, s68
  s_add_u32 s63, s63, s3
  s_cmp_eq_u32 s65, 7
  s_cselect_b32 s3, 4293591040, s69
  s_add_u32 s64, s64, s3
  s_waitcnt lgkmcnt(4)
  v_mfma_f32_16x16x32_bf16 v[176:179], a[208:211], a[192:195], v[176:179]
  v_lshlrev_b32 v3, 1, v3
  v_mfma_f32_16x16x32_bf16 v[184:187], a[208:211], a[196:199], v[184:187]
  v_lshlrev_b32 v4, 2, v2
  v_mfma_f32_16x16x32_bf16 v[192:195], a[208:211], a[200:203], v[192:195]
  ds_read_b32 v5, v40
  s_waitcnt vmcnt(8) lgkmcnt(1)
  s_barrier
  s_add_u32 m0, s66, 65536
  ds_read_b64_tr_b16 a[176:177], v29 offset:0
  buffer_load_dwordx4 v12, s[28:31], s63 offen offset:0 lds
  v_mfma_f32_16x16x32_bf16 v[200:203], a[208:211], a[204:207], v[200:203]
  v_xor_b32 v3, v3, v4
  buffer_load_dwordx4 v13, s[28:31], s63 offen offset:1024 lds
  ds_read_b64_tr_b16 a[178:179], v29 offset:1024
  v_mfma_f32_16x16x32_bf16 v[204:207], a[212:215], a[204:207], v[204:207]
  ds_read_b128 a[160:163], v25 offset:0
  v_mfma_f32_16x16x32_bf16 v[196:199], a[212:215], a[200:203], v[196:199]
  v_lshlrev_b32 v3, 4, v3
  ds_read_b128 a[164:167], v25 offset:2048
  v_mfma_f32_16x16x32_bf16 v[188:191], a[212:215], a[196:199], v[188:191]
  ds_read_b128 a[168:171], v25 offset:4096
  v_mfma_f32_16x16x32_bf16 v[180:183], a[212:215], a[192:195], v[180:183]
  buffer_load_dwordx4 v14, s[28:31], s63 offen offset:2048 lds
  v_lshl_add_u32 v3, v2, 8, v3
  ds_read_b128 a[172:175], v25 offset:6144
  v_mfma_f32_16x16x32_bf16 v[208:211], a[216:219], a[192:195], v[208:211]
  v_lshl_add_u32 v3, v9, 10, v3
  ds_read_b64_tr_b16 a[180:181], v30 offset:0
  v_mfma_f32_16x16x32_bf16 v[216:219], a[216:219], a[196:199], v[216:219]
  ds_read_b64_tr_b16 a[182:183], v30 offset:1024
  v_mfma_f32_16x16x32_bf16 v[224:227], a[216:219], a[200:203], v[224:227]
  s_lshl_b32 s71, s60, 11
  ds_read_b64_tr_b16 a[184:185], v31 offset:0
  buffer_load_dwordx4 v15, s[28:31], s63 offen offset:3072 lds
  v_mfma_f32_16x16x32_bf16 v[232:235], a[216:219], a[204:207], v[232:235]
  ds_read_b64_tr_b16 a[186:187], v31 offset:1024
  v_mfma_f32_16x16x32_bf16 v[236:239], a[220:223], a[204:207], v[236:239]
  s_add_u32 s70, s71, 32768
  ds_read_b64_tr_b16 a[188:189], v32 offset:0
  v_mfma_f32_16x16x32_bf16 v[228:231], a[220:223], a[200:203], v[228:231]
  ds_read_b64_tr_b16 a[190:191], v32 offset:1024
  v_mfma_f32_16x16x32_bf16 v[220:223], a[220:223], a[196:199], v[220:223]
  v_add_u32 v87, s70, v3
  s_add_u32 m0, s66, 81920
  s_nop 0
  buffer_load_dwordx4 v16, s[40:43], s64 offen offset:0 lds
  v_mfma_f32_16x16x32_bf16 v[212:215], a[220:223], a[192:195], v[212:215]
  s_waitcnt lgkmcnt(4)
  v_mfma_f32_16x16x32_bf16 v[176:179], a[176:179], a[160:163], v[176:179]
  s_lshl_b32 s32, s62, 5
  s_cmp_eq_u32 s74, 3
  s_cbranch_scc1 DOX3
NOX3:
  ds_read_b64_tr_b16 a[208:209], v29 offset:8192
  v_mfma_f32_16x16x32_bf16 v[184:187], a[176:179], a[164:167], v[184:187]
  s_add_u32 s32, s32, s61
  ds_read_b64_tr_b16 a[210:211], v29 offset:9216
  v_mfma_f32_16x16x32_bf16 v[192:195], a[176:179], a[168:171], v[192:195]
  buffer_load_dwordx4 v17, s[40:43], s64 offen offset:1024 lds
  ds_read_b128 a[192:195], v26 offset:0
  v_mfma_f32_16x16x32_bf16 v[200:203], a[176:179], a[172:175], v[200:203]
  s_lshl_b32 s32, s32, 13
  ds_read_b128 a[196:199], v26 offset:2048
  v_mfma_f32_16x16x32_bf16 v[204:207], a[180:183], a[172:175], v[204:207]
  ds_read_b128 a[200:203], v26 offset:4096
  v_mfma_f32_16x16x32_bf16 v[196:199], a[180:183], a[168:171], v[196:199]
  s_add_u32 s32, s32, 3801088
  ds_read_b128 a[204:207], v26 offset:6144
  v_mfma_f32_16x16x32_bf16 v[188:191], a[180:183], a[164:167], v[188:191]
  buffer_load_dwordx4 v18, s[40:43], s64 offen offset:2048 lds
  v_mfma_f32_16x16x32_bf16 v[180:183], a[180:183], a[160:163], v[180:183]
  s_lshl_b32 s33, s62, 18
  s_waitcnt lgkmcnt(6)
  v_mfma_f32_16x16x32_bf16 v[208:211], a[184:187], a[160:163], v[208:211]
  s_lshl_b32 s70, s61, 8
  ds_read_b64_tr_b16 a[212:213], v30 offset:8192
  v_mfma_f32_16x16x32_bf16 v[216:219], a[184:187], a[164:167], v[216:219]
  ds_read_b64_tr_b16 a[214:215], v30 offset:9216
  v_mfma_f32_16x16x32_bf16 v[224:227], a[184:187], a[168:171], v[224:227]
  s_add_u32 s33, s33, s70
  buffer_load_dwordx4 v19, s[40:43], s64 offen offset:3072 lds
  s_add_u32 s65, s65, 1
  s_cmp_eq_u32 s65, 7
  s_cselect_b32 s3, 4294966528, s68
  s_add_u32 s63, s63, s3
  s_cmp_eq_u32 s65, 7
  s_cselect_b32 s3, 4293591040, s69
  s_add_u32 s64, s64, s3
  ds_read_b64_tr_b16 a[216:217], v31 offset:8192
  v_mfma_f32_16x16x32_bf16 v[232:235], a[184:187], a[172:175], v[232:235]
  ds_read_b64_tr_b16 a[218:219], v31 offset:9216
  v_mfma_f32_16x16x32_bf16 v[236:239], a[188:191], a[172:175], v[236:239]
  s_add_u32 s33, s33, 3801088
  ds_read_b64_tr_b16 a[220:221], v32 offset:8192
  v_mfma_f32_16x16x32_bf16 v[228:231], a[188:191], a[168:171], v[228:231]
  ds_read_b64_tr_b16 a[222:223], v32 offset:9216
  v_mfma_f32_16x16x32_bf16 v[220:223], a[188:191], a[164:167], v[220:223]
  v_lshlrev_b32 v1, 4, v7
  v_mfma_f32_16x16x32_bf16 v[212:215], a[188:191], a[160:163], v[212:215]
  s_load_dwordx8 s[92:99], s[26:27], s82 glc
  s_waitcnt lgkmcnt(4)
  v_mfma_f32_16x16x32_bf16 v[176:179], a[208:211], a[192:195], v[176:179]
  v_lshl_add_u32 v88, v11, 8, v1
  v_mfma_f32_16x16x32_bf16 v[184:187], a[208:211], a[196:199], v[184:187]
  v_lshl_add_u32 v90, v11, 13, v1
  v_mfma_f32_16x16x32_bf16 v[192:195], a[208:211], a[200:203], v[192:195]
  ds_read_b32 v5, v40
  ds_read_b32 v5, v40
  ds_read_b32 v5, v40
  s_waitcnt vmcnt(8) lgkmcnt(3)
  s_barrier
  s_mov_b32 m0, s66
  ds_read_b64_tr_b16 a[176:177], v29 offset:32768
  buffer_load_dwordx4 v12, s[28:31], s63 offen offset:0 lds
  buffer_load_dwordx4 v13, s[28:31], s63 offen offset:1024 lds
  v_mfma_f32_16x16x32_bf16 v[200:203], a[208:211], a[204:207], v[200:203]
  s_mul_i32 s35, s61, 7
  ds_read_b64_tr_b16 a[178:179], v29 offset:33792
  v_mfma_f32_16x16x32_bf16 v[204:207], a[212:215], a[204:207], v[204:207]
  ds_read_b128 a[160:163], v25 offset:32768
  v_mfma_f32_16x16x32_bf16 v[196:199], a[212:215], a[200:203], v[196:199]
  s_add_u32 s35, s35, s62
  ds_read_b128 a[164:167], v25 offset:34816
  v_mfma_f32_16x16x32_bf16 v[188:191], a[212:215], a[196:199], v[188:191]
  buffer_load_dwordx4 v14, s[28:31], s63 offen offset:2048 lds
  ds_read_b128 a[168:171], v25 offset:36864
  v_mfma_f32_16x16x32_bf16 v[180:183], a[212:215], a[192:195], v[180:183]
  s_xor_b32 s34, s61, 1
  ds_read_b128 a[172:175], v25 offset:38912
  v_mfma_f32_16x16x32_bf16 v[208:211], a[216:219], a[192:195], v[208:211]
  s_mul_i32 s34, s34, 7
  ds_read_b64_tr_b16 a[180:181], v30 offset:32768
  v_mfma_f32_16x16x32_bf16 v[216:219], a[216:219], a[196:199], v[216:219]
  ds_read_b64_tr_b16 a[182:183], v30 offset:33792
  v_mfma_f32_16x16x32_bf16 v[224:227], a[216:219], a[200:203], v[224:227]
  buffer_load_dwordx4 v15, s[28:31], s63 offen offset:3072 lds
  s_add_u32 s34, s34, s62
  ds_read_b64_tr_b16 a[184:185], v31 offset:32768
  v_mfma_f32_16x16x32_bf16 v[232:235], a[216:219], a[204:207], v[232:235]
  ds_read_b64_tr_b16 a[186:187], v31 offset:33792
  v_mfma_f32_16x16x32_bf16 v[236:239], a[220:223], a[204:207], v[236:239]
  s_add_u32 s36, s81, 49152
  ds_read_b64_tr_b16 a[188:189], v32 offset:32768
  v_mfma_f32_16x16x32_bf16 v[228:231], a[220:223], a[200:203], v[228:231]
  ds_read_b64_tr_b16 a[190:191], v32 offset:33792
  s_add_u32 m0, s66, 16384
  v_mfma_f32_16x16x32_bf16 v[220:223], a[220:223], a[196:199], v[220:223]
  buffer_load_dwordx4 v16, s[40:43], s64 offen offset:0 lds
  s_lshl_b32 s37, s62, 2
  v_mfma_f32_16x16x32_bf16 v[212:215], a[220:223], a[192:195], v[212:215]
  s_waitcnt lgkmcnt(4)
  v_mfma_f32_16x16x32_bf16 v[176:179], a[176:179], a[160:163], v[176:179]
  s_add_u32 s37, s37, s60
  s_cmp_eq_u32 s74, 4
  s_cbranch_scc1 DOX4
NOX4:
  ds_read_b64_tr_b16 a[208:209], v29 offset:40960
  v_mfma_f32_16x16x32_bf16 v[184:187], a[176:179], a[164:167], v[184:187]
  s_lshl_b32 s37, s37, 2
  ds_read_b64_tr_b16 a[210:211], v29 offset:41984
  buffer_load_dwordx4 v17, s[40:43], s64 offen offset:1024 lds
  v_mfma_f32_16x16x32_bf16 v[192:195], a[176:179], a[168:171], v[192:195]
  ds_read_b128 a[192:195], v26 offset:32768
  v_mfma_f32_16x16x32_bf16 v[200:203], a[176:179], a[172:175], v[200:203]
  s_lshr_b32 s70, s61, 3
  ds_read_b128 a[196:199], v26 offset:34816
  v_mfma_f32_16x16x32_bf16 v[204:207], a[180:183], a[172:175], v[204:207]
  ds_read_b128 a[200:203], v26 offset:36864
  v_mfma_f32_16x16x32_bf16 v[196:199], a[180:183], a[168:171], v[196:199]
  s_add_u32 s37, s37, s70
  ds_read_b128 a[204:207], v26 offset:38912
  buffer_load_dwordx4 v18, s[40:43], s64 offen offset:2048 lds
  v_mfma_f32_16x16x32_bf16 v[188:191], a[180:183], a[164:167], v[188:191]
  v_mfma_f32_16x16x32_bf16 v[180:183], a[180:183], a[160:163], v[180:183]
  s_lshl_b32 s37, s37, 7
  s_waitcnt lgkmcnt(6)
  v_mfma_f32_16x16x32_bf16 v[208:211], a[184:187], a[160:163], v[208:211]
  s_add_u32 s37, s37, 53248
  ds_read_b64_tr_b16 a[212:213], v30 offset:40960
  v_mfma_f32_16x16x32_bf16 v[216:219], a[184:187], a[164:167], v[216:219]
  ds_read_b64_tr_b16 a[214:215], v30 offset:41984
  buffer_load_dwordx4 v19, s[40:43], s64 offen offset:3072 lds
  v_mfma_f32_16x16x32_bf16 v[224:227], a[184:187], a[168:171], v[224:227]
  s_lshl_b32 s70, s60, 7
  ds_read_b64_tr_b16 a[216:217], v31 offset:40960
  v_mfma_f32_16x16x32_bf16 v[232:235], a[184:187], a[172:175], v[232:235]
  ds_read_b64_tr_b16 a[218:219], v31 offset:41984
  v_mfma_f32_16x16x32_bf16 v[236:239], a[188:191], a[172:175], v[236:239]
  s_add_u32 s70, s70, 131072
  ds_read_b64_tr_b16 a[220:221], v32 offset:40960
  v_mfma_f32_16x16x32_bf16 v[228:231], a[188:191], a[168:171], v[228:231]
  ds_read_b64_tr_b16 a[222:223], v32 offset:41984
  v_mfma_f32_16x16x32_bf16 v[220:223], a[188:191], a[164:167], v[220:223]
  s_lshl_b32 s38, s34, 9
  v_mfma_f32_16x16x32_bf16 v[212:215], a[188:191], a[160:163], v[212:215]
  s_waitcnt lgkmcnt(4)
  v_mfma_f32_16x16x32_bf16 v[176:179], a[208:211], a[192:195], v[176:179]
  s_lshl_b32 s39, s35, 9
  s_waitcnt lgkmcnt(0)
  s_xor_b64 s[92:93], s[92:93], s[100:101]
  s_xor_b64 s[94:95], s[94:95], s[100:101]
  v_mfma_f32_16x16x32_bf16 v[184:187], a[208:211], a[196:199], v[184:187]
  s_add_u32 s38, s38, s70
  s_xor_b64 s[96:97], s[96:97], s[100:101]
  s_xor_b64 s[98:99], s[98:99], s[100:101]
  s_or_b64 s[92:93], s[92:93], s[94:95]
  v_mfma_f32_16x16x32_bf16 v[192:195], a[208:211], a[200:203], v[192:195]
  s_or_b64 s[96:97], s[96:97], s[98:99]
  s_or_b64 s[92:93], s[92:93], s[96:97]
  s_cbranch_scc1 RETRY1
OK1:
  s_waitcnt vmcnt(8)
  s_barrier
  s_add_u32 m0, s67, 32768
  ds_read_b64_tr_b16 a[176:177], v33 offset:0
  buffer_load_dwordx4 v46, s[44:47], s89 offen offset:0 lds
  buffer_load_dwordx4 v47, s[44:47], s89 offen offset:1024 lds
  v_mfma_f32_16x16x32_bf16 v[200:203], a[208:211], a[204:207], v[200:203]
  s_add_u32 s39, s39, s70
  ds_read_b64_tr_b16 a[178:179], v33 offset:1024
  v_mfma_f32_16x16x32_bf16 v[204:207], a[212:215], a[204:207], v[204:207]
  ds_read_b128 a[160:163], v27 offset:0
  buffer_load_dwordx4 v48, s[44:47], s89 offen offset:2048 lds
  v_mfma_f32_16x16x32_bf16 v[196:199], a[212:215], a[200:203], v[196:199]
  s_mul_i32 s70, s60, 3072
  ds_read_b128 a[164:167], v27 offset:2048
  v_mfma_f32_16x16x32_bf16 v[188:191], a[212:215], a[196:199], v[188:191]
  ds_read_b128 a[168:171], v27 offset:4096
  v_mfma_f32_16x16x32_bf16 v[180:183], a[212:215], a[192:195], v[180:183]
  s_add_u32 s70, s70, 13893632
  ds_read_b128 a[172:175], v27 offset:6144
  buffer_load_dwordx4 v49, s[44:47], s89 offen offset:3072 lds
  s_add_u32 s89, s89, 28672
  v_mfma_f32_16x16x32_bf16 v[208:211], a[216:219], a[192:195], v[208:211]
  s_mul_i32 s35, s35, 12288
  ds_read_b64_tr_b16 a[180:181], v34 offset:0
  v_mfma_f32_16x16x32_bf16 v[216:219], a[216:219], a[196:199], v[216:219]
  ds_read_b64_tr_b16 a[182:183], v34 offset:1024
  s_add_u32 m0, s67, 36864
  v_mfma_f32_16x16x32_bf16 v[224:227], a[216:219], a[200:203], v[224:227]
  buffer_load_dwordx4 v46, s[44:47], s89 offen offset:0 lds
  s_mul_i32 s34, s34, 12288
  ds_read_b64_tr_b16 a[184:185], v35 offset:0
  v_mfma_f32_16x16x32_bf16 v[232:235], a[216:219], a[204:207], v[232:235]
  ds_read_b64_tr_b16 a[186:187], v35 offset:1024
  v_mfma_f32_16x16x32_bf16 v[236:239], a[220:223], a[204:207], v[236:239]
  s_add_u32 s35, s35, s70
  ds_read_b64_tr_b16 a[188:189], v36 offset:0
  v_mfma_f32_16x16x32_bf16 v[228:231], a[220:223], a[200:203], v[228:231]
  buffer_load_dwordx4 v47, s[44:47], s89 offen offset:1024 lds
  ds_read_b64_tr_b16 a[190:191], v36 offset:1024
  v_mfma_f32_16x16x32_bf16 v[220:223], a[220:223], a[196:199], v[220:223]
  s_add_u32 s34, s34, s70
  v_mfma_f32_16x16x32_bf16 v[212:215], a[220:223], a[192:195], v[212:215]
  s_waitcnt lgkmcnt(4)
  v_mfma_f32_16x16x32_bf16 v[176:179], a[176:179], a[160:163], v[176:179]
  buffer_load_dwordx4 v48, s[44:47], s89 offen offset:2048 lds
  s_cmp_eq_u32 s74, 5
  s_cbranch_scc1 DOX5
NOX5:
  ds_read_b64_tr_b16 a[208:209], v33 offset:8192
  ds_write_b128 v59, v[40:43]
  v_mfma_f32_16x16x32_bf16 v[184:187], a[176:179], a[164:167], v[184:187]
  ds_read_b64_tr_b16 a[210:211], v33 offset:9216
  v_mfma_f32_16x16x32_bf16 v[192:195], a[176:179], a[168:171], v[192:195]
  buffer_load_dwordx4 v49, s[44:47], s89 offen offset:3072 lds
  s_add_u32 s89, s89, 28672
  ds_read_b128 a[192:195], v28 offset:0
  v_mfma_f32_16x16x32_bf16 v[200:203], a[176:179], a[172:175], v[200:203]
  ds_read_b128 a[196:199], v28 offset:2048
  v_mfma_f32_16x16x32_bf16 v[204:207], a[180:183], a[172:175], v[204:207]
  ds_read_b128 a[200:203], v28 offset:4096
  v_mfma_f32_16x16x32_bf16 v[196:199], a[180:183], a[168:171], v[196:199]
  buffer_load_dwordx4 v[152:155], v60, s[52:55], s91 offen offset:0 sc1
  ds_read_b128 a[204:207], v28 offset:6144
  v_mfma_f32_16x16x32_bf16 v[188:191], a[180:183], a[164:167], v[188:191]
  v_mfma_f32_16x16x32_bf16 v[180:183], a[180:183], a[160:163], v[180:183]
  s_waitcnt lgkmcnt(7)
  v_mfma_f32_16x16x32_bf16 v[208:211], a[184:187], a[160:163], v[208:211]
  ds_read_b64_tr_b16 a[212:213], v34 offset:8192
  buffer_load_dwordx4 v[156:159], v60, s[52:55], s91 offen offset:128 sc1
  v_mov_b32 v242, 0
  v_mov_b32 v243, 0
  v_mfma_f32_16x16x32_bf16 v[216:219], a[184:187], a[164:167], v[216:219]
  ds_read_b64_tr_b16 a[214:215], v34 offset:9216
  v_mov_b32 v246, 0
  v_mfma_f32_16x16x32_bf16 v[224:227], a[184:187], a[168:171], v[224:227]
  ds_read_b64_tr_b16 a[216:217], v35 offset:8192
  v_mov_b32 v247, 0
  v_mfma_f32_16x16x32_bf16 v[232:235], a[184:187], a[172:175], v[232:235]
  buffer_load_dwordx4 v[160:163], v60, s[52:55], s91 offen offset:256 sc1
  ds_read_b64_tr_b16 a[218:219], v35 offset:9216
  v_mov_b32 v250, 0
  v_mfma_f32_16x16x32_bf16 v[236:239], a[188:191], a[172:175], v[236:239]
  ds_read_b64_tr_b16 a[220:221], v36 offset:8192
  v_mov_b32 v251, 0
  v_mov_b32 v254, 0
  v_mfma_f32_16x16x32_bf16 v[228:231], a[188:191], a[168:171], v[228:231]
  ds_read_b64_tr_b16 a[222:223], v36 offset:9216
  v_mov_b32 v255, 0
  buffer_load_dwordx4 v[136:139], v10, s[52:55], s78 offen sc1
  v_mfma_f32_16x16x32_bf16 v[220:223], a[188:191], a[164:167], v[220:223]
  v_mov_b32 v172, 0
  v_mfma_f32_16x16x32_bf16 v[212:215], a[188:191], a[160:163], v[212:215]
  v_mov_b32 v173, 0
  s_waitcnt lgkmcnt(4)
  v_mfma_f32_16x16x32_bf16 v[176:179], a[208:211], a[192:195], v[176:179]
  v_mfma_f32_16x16x32_bf16 v[184:187], a[208:211], a[196:199], v[184:187]
  buffer_load_dwordx4 v[140:143], v10, s[52:55], s79 offen sc1
  v_mfma_f32_16x16x32_bf16 v[192:195], a[208:211], a[200:203], v[192:195]
  s_waitcnt vmcnt(13) lgkmcnt(0)
  s_barrier
  ds_read_b64_tr_b16 a[176:177], v29 offset:0
  v_mfma_f32_16x16x32_bf16 v[200:203], a[208:211], a[204:207], v[200:203]
  ds_read_b64_tr_b16 a[178:179], v29 offset:1024
  v_mfma_f32_16x16x32_bf16 v[204:207], a[212:215], a[204:207], v[204:207]
  ds_read_b128 a[160:163], v25 offset:0
  v_mfma_f32_16x16x32_bf16 v[196:199], a[212:215], a[200:203], v[196:199]
  ds_read_b128 a[164:167], v25 offset:2048
  v_mfma_f32_16x16x32_bf16 v[188:191], a[212:215], a[196:199], v[188:191]
  ds_read_b128 a[168:171], v25 offset:4096
  v_mfma_f32_16x16x32_bf16 v[180:183], a[212:215], a[192:195], v[180:183]
  ds_read_b128 a[172:175], v25 offset:6144
  v_mfma_f32_16x16x32_bf16 v[208:211], a[216:219], a[192:195], v[208:211]
  ds_read_b64_tr_b16 a[180:181], v30 offset:0
  v_mfma_f32_16x16x32_bf16 v[216:219], a[216:219], a[196:199], v[216:219]
  ds_read_b64_tr_b16 a[182:183], v30 offset:1024
  v_mfma_f32_16x16x32_bf16 v[224:227], a[216:219], a[200:203], v[224:227]
  ds_read_b64_tr_b16 a[184:185], v31 offset:0
PG2:
  s_cbranch_execz PG3
  v_mfma_f32_16x16x32_bf16 v[232:235], a[216:219], a[204:207], v[232:235]
  ds_read_b64_tr_b16 a[186:187], v31 offset:1024
  v_mfma_f32_16x16x32_bf16 v[236:239], a[220:223], a[204:207], v[236:239]
  ds_read_b64_tr_b16 a[188:189], v32 offset:0
  v_mfma_f32_16x16x32_bf16 v[228:231], a[220:223], a[200:203], v[228:231]
  ds_read_b64_tr_b16 a[190:191], v32 offset:1024
  v_mfma_f32_16x16x32_bf16 v[220:223], a[220:223], a[196:199], v[220:223]
  v_mfma_f32_16x16x32_bf16 v[212:215], a[220:223], a[192:195], v[212:215]
  s_waitcnt lgkmcnt(4)
  v_mfma_f32_16x16x32_bf16 v[176:179], a[176:179], a[160:163], v[176:179]
  s_cmp_eq_u32 s74, 6
  s_cbranch_scc1 DOX6
NOX6:
  ds_read_b64_tr_b16 a[208:209], v29 offset:8192
  v_mfma_f32_16x16x32_bf16 v[184:187], a[176:179], a[164:167], v[184:187]
  ds_read_b64_tr_b16 a[210:211], v29 offset:9216
  v_mfma_f32_16x16x32_bf16 v[192:195], a[176:179], a[168:171], v[192:195]
  ds_read_b128 a[192:195], v26 offset:0
  v_mfma_f32_16x16x32_bf16 v[200:203], a[176:179], a[172:175], v[200:203]
  ds_read_b128 a[196:199], v26 offset:2048
  v_mfma_f32_16x16x32_bf16 v[204:207], a[180:183], a[172:175], v[204:207]
  ds_read_b128 a[200:203], v26 offset:4096
  v_mfma_f32_16x16x32_bf16 v[196:199], a[180:183], a[168:171], v[196:199]
  ds_read_b128 a[204:207], v26 offset:6144
  v_mfma_f32_16x16x32_bf16 v[188:191], a[180:183], a[164:167], v[188:191]
  v_mfma_f32_16x16x32_bf16 v[180:183], a[180:183], a[160:163], v[180:183]
  s_waitcnt lgkmcnt(6)
  v_mfma_f32_16x16x32_bf16 v[208:211], a[184:187], a[160:163], v[208:211]
  ds_read_b64_tr_b16 a[212:213], v30 offset:8192
  s_waitcnt vmcnt(2)
  v_cmp_ne_u32 vcc, s100, v155
  v_mfma_f32_16x16x32_bf16 v[216:219], a[184:187], a[164:167], v[216:219]
  ds_read_b64_tr_b16 a[214:215], v30 offset:9216
  v_cmp_ne_u32 s[92:93], s100, v159
  v_cmp_ne_u32 s[94:95], s100, v163
  v_mfma_f32_16x16x32_bf16 v[224:227], a[184:187], a[168:171], v[224:227]
  ds_read_b64_tr_b16 a[216:217], v31 offset:8192
  s_or_b64 vcc, vcc, s[92:93]
  s_or_b64 vcc, vcc, s[94:95]
  s_cbranch_scc1 RETRY0
OK0:
  v_mfma_f32_16x16x32_bf16 v[232:235], a[184:187], a[172:175], v[232:235]
  ds_read_b64_tr_b16 a[218:219], v31 offset:9216
  v_mov_b32 v155, v160
  v_mov_b32 v159, v161
  v_mfma_f32_16x16x32_bf16 v[236:239], a[188:191], a[172:175], v[236:239]
  ds_read_b64_tr_b16 a[220:221], v32 offset:8192
  v_lshrrev_b32 v163, 16, v162
  v_mfma_f32_16x16x32_bf16 v[228:231], a[188:191], a[168:171], v[228:231]
  ds_read_b64_tr_b16 a[222:223], v32 offset:9216
  ds_write_b128 v58, v[152:155] offset:4576
  ds_write_b128 v58, v[156:159] offset:13728
  v_mfma_f32_16x16x32_bf16 v[220:223], a[188:191], a[164:167], v[220:223]
  v_alignbyte_b32 v144, v153, v152, 2
  v_mfma_f32_16x16x32_bf16 v[212:215], a[188:191], a[160:163], v[212:215]
  v_alignbyte_b32 v145, v154, v153, 2
  s_waitcnt lgkmcnt(8)
  v_mfma_f32_16x16x32_bf16 v[176:179], a[208:211], a[192:195], v[176:179]
  v_alignbyte_b32 v146, v155, v154, 2
  v_alignbyte_b32 v147, v162, v155, 2
  s_waitcnt vmcnt(0)
  v_cmp_ne_u32 vcc, s100, v139
  s_waitcnt lgkmcnt(6)
  v_mfma_f32_16x16x32_bf16 v[180:183], a[212:215], a[192:195], v[180:183]
  ds_write_b128 v58, v[144:147] offset:0
  v_cmp_ne_u32 s[92:93], s100, v142
  s_nop 0
  s_or_b64 vcc, vcc, s[92:93]
  s_cbranch_scc1 RETRY2
OK2:
  v_mov_b32 v165, v137
  v_mfma_f32_16x16x32_bf16 v[184:187], a[208:211], a[196:199], v[184:187]
  v_alignbyte_b32 v148, v157, v156, 2
  v_mov_b32 v167, v137
  v_cmp_eq_u32 vcc, 0, v8
  v_mfma_f32_16x16x32_bf16 v[188:191], a[212:215], a[196:199], v[188:191]
  v_alignbyte_b32 v149, v158, v157, 2
  v_alignbyte_b32 v150, v159, v158, 2
  v_cmp_eq_u32 s[92:93], 1, v8
  v_permlane16_swap_b32 v165, v167
  v_cndmask_b32 v240, 0, v140, vcc
  v_mfma_f32_16x16x32_bf16 v[192:195], a[208:211], a[200:203], v[192:195]
  v_alignbyte_b32 v151, v163, v159, 2
  v_mov_b32 v169, v165
  v_mov_b32 v171, v167
  v_mfma_f32_16x16x32_bf16 v[196:199], a[212:215], a[200:203], v[196:199]
  ds_write_b128 v58, v[148:151] offset:9152
  v_cndmask_b32 v241, 0, v141, vcc
  v_cndmask_b32 v244, 0, v140, s[92:93]
  v_permlane32_swap_b32 v165, v169
  v_mfma_f32_16x16x32_bf16 v[200:203], a[208:211], a[204:207], v[200:203]
  v_permlane32_swap_b32 v167, v171
  v_cndmask_b32 v245, 0, v141, s[92:93]
  ds_read_b128 a[112:115], v56 offset:0
  v_mfma_f32_16x16x32_bf16 v[204:207], a[212:215], a[204:207], v[204:207]
  s_mov_b32 s94, 0x01000100
  v_perm_b32 v164, v165, v165, s94
  v_perm_b32 v166, v167, v167, s94
  ds_read_b128 a[116:119], v56 offset:512
  s_waitcnt lgkmcnt(8)
  v_mfma_f32_16x16x32_bf16 v[208:211], a[216:219], a[192:195], v[208:211]
  v_perm_b32 v168, v169, v169, s94
  v_perm_b32 v170, v171, v171, s94
  ds_read_b128 a[120:123], v56 offset:1024
  s_waitcnt lgkmcnt(7)
  v_mfma_f32_16x16x32_bf16 v[212:215], a[220:223], a[192:195], v[212:215]
  ds_write_b32 v69, v137
  ds_read_b128 a[124:127], v56 offset:1536
  v_mfma_f32_16x16x32_bf16 v[176:179], v[240:243], v[164:167], v[176:179]
  v_cmp_eq_u32 vcc, 2, v8
  v_cmp_eq_u32 s[92:93], 3, v8
  v_mfma_f32_16x16x32_bf16 v[180:183], v[244:247], v[164:167], v[180:183]
  v_cndmask_b32 v248, 0, v140, vcc
  v_cndmask_b32 v249, 0, v141, vcc
  ds_read_b128 a[128:131], v56 offset:2048
  v_mfma_f32_16x16x32_bf16 v[216:219], a[216:219], a[196:199], v[216:219]
  v_cndmask_b32 v252, 0, v140, s[92:93]
  v_cndmask_b32 v253, 0, v141, s[92:93]
  ds_read_b128 a[132:135], v56 offset:2560
  v_mfma_f32_16x16x32_bf16 v[220:223], a[220:223], a[196:199], v[220:223]
  ds_read_b128 a[136:139], v56 offset:3072
  v_mfma_f32_16x16x32_bf16 v[184:187], v[240:243], v[166:169], v[184:187]
  ds_read_b128 a[140:143], v56 offset:3584
  v_cvt_pk_bf16_f32 v112, v176, v177
  v_cvt_pk_bf16_f32 v113, v178, v179
  v_cvt_pk_bf16_f32 v114, v180, v181
  v_mfma_f32_16x16x32_bf16 v[188:191], v[244:247], v[166:169], v[188:191]
  v_cvt_pk_bf16_f32 v115, v182, v183
  v_pk_max_i16 v112, v112, 0
  v_mfma_f32_16x16x32_bf16 v[224:227], a[216:219], a[200:203], v[224:227]
  v_pk_max_i16 v113, v113, 0
  v_pk_max_i16 v114, v114, 0
  v_mfma_f32_16x16x32_bf16 v[228:231], a[220:223], a[200:203], v[228:231]
  v_pk_max_i16 v115, v115, 0
  v_mfma_f32_16x16x32_bf16 v[192:195], v[240:243], v[168:171], v[192:195]
  buffer_store_dwordx4 v[112:115], v44, s[52:55], s86 offen offset:0 sc1
  s_waitcnt lgkmcnt(5)
  s_barrier
  v_cvt_pk_bf16_f32 v116, v184, v185
  v_cvt_pk_bf16_f32 v117, v186, v187
  v_cvt_pk_bf16_f32 v118, v188, v189
  v_mfma_f32_16x16x32_bf16 v[196:199], v[244:247], v[168:171], v[196:199]
  ds_read_b128 a[144:147], v57 offset:3584
  v_cvt_pk_bf16_f32 v119, v190, v191
  v_pk_max_i16 v116, v116, 0
  v_mfma_f32_16x16x32_bf16 v[232:235], a[216:219], a[204:207], v[232:235]
  ds_read_b128 a[148:151], v57 offset:3072
  v_pk_max_i16 v117, v117, 0
  v_pk_max_i16 v118, v118, 0
  v_mfma_f32_16x16x32_bf16 v[236:239], a[220:223], a[204:207], v[236:239]
  ds_read_b128 a[152:155], v57 offset:2560
  v_pk_max_i16 v119, v119, 0
  v_mfma_f32_16x16x32_bf16 v[200:203], v[240:243], v[170:173], v[200:203]
  buffer_store_dwordx4 v[116:119], v44, s[52:55], s86 offen offset:256 sc1
  ds_read_b128 a[156:159], v57 offset:2048
  v_cvt_pk_bf16_f32 v120, v192, v193
  v_cvt_pk_bf16_f32 v121, v194, v195
  v_cvt_pk_bf16_f32 v122, v196, v197
  v_mfma_f32_16x16x32_bf16 v[204:207], v[244:247], v[170:173], v[204:207]
  ds_read_b128 a[160:163], v57 offset:1536
  v_cvt_pk_bf16_f32 v123, v198, v199
  v_pk_max_i16 v120, v120, 0
  v_mfma_f32_16x16x32_bf16 v[208:211], v[248:251], v[164:167], v[208:211]
  ds_read_b128 a[164:167], v57 offset:1024
  v_pk_max_i16 v121, v121, 0
  v_pk_max_i16 v122, v122, 0
  v_mfma_f32_16x16x32_bf16 v[212:215], v[252:255], v[164:167], v[212:215]
  ds_read_b128 a[168:171], v57 offset:512
  v_pk_max_i16 v123, v123, 0
  v_mfma_f32_16x16x32_bf16 v[216:219], v[248:251], v[166:169], v[216:219]
  buffer_store_dwordx4 v[120:123], v45, s[52:55], s86 offen offset:0 sc1
  ds_read_b128 a[172:175], v57 offset:0
  v_cvt_pk_bf16_f32 v124, v200, v201
  v_cvt_pk_bf16_f32 v125, v202, v203
  v_cvt_pk_bf16_f32 v126, v204, v205
  v_mfma_f32_16x16x32_bf16 v[220:223], v[252:255], v[166:169], v[220:223]
  v_cvt_pk_bf16_f32 v127, v206, v207
  v_pk_max_i16 v124, v124, 0
  v_mfma_f32_16x16x32_bf16 v[224:227], v[248:251], v[168:171], v[224:227]
  v_pk_max_i16 v125, v125, 0
  v_pk_max_i16 v126, v126, 0
  v_mfma_f32_16x16x32_bf16 v[228:231], v[252:255], v[168:171], v[228:231]
  v_pk_max_i16 v127, v127, 0
  v_mfma_f32_16x16x32_bf16 v[232:235], v[248:251], v[170:173], v[232:235]
  buffer_store_dwordx4 v[124:127], v45, s[52:55], s86 offen offset:256 sc1
  v_mfma_f32_16x16x32_bf16 v[236:239], v[252:255], v[170:173], v[236:239]
  s_waitcnt lgkmcnt(7)
  v_mfma_f32_16x16x32_bf16 a[224:227], a[112:115], a[144:147], 0
  v_mfma_f32_16x16x32_bf16 a[224:227], v[64:67], a[144:147], a[224:227]
  s_waitcnt lgkmcnt(6)
  v_mfma_f32_16x16x32_bf16 a[228:231], a[112:115], a[148:151], 0
  v_cvt_pk_bf16_f32 v128, v208, v209
  v_cvt_pk_bf16_f32 v129, v210, v211
  v_mfma_f32_16x16x32_bf16 a[228:231], v[64:67], a[148:151], a[228:231]
  v_mfma_f32_16x16x32_bf16 a[228:231], a[116:119], a[144:147], a[228:231]
  v_cvt_pk_bf16_f32 v130, v212, v213
  v_cvt_pk_bf16_f32 v131, v214, v215
  s_waitcnt lgkmcnt(5)
  v_mfma_f32_16x16x32_bf16 a[232:235], a[112:115], a[152:155], 0
  v_pk_max_i16 v128, v128, 0
  v_pk_max_i16 v129, v129, 0
  v_mfma_f32_16x16x32_bf16 a[232:235], v[64:67], a[152:155], a[232:235]
  v_mfma_f32_16x16x32_bf16 a[232:235], a[116:119], a[148:151], a[232:235]
  v_pk_max_i16 v130, v130, 0
  v_pk_max_i16 v131, v131, 0
  v_mfma_f32_16x16x32_bf16 a[232:235], a[120:123], a[144:147], a[232:235]
  v_cvt_pk_bf16_f32 v132, v216, v217
  buffer_store_dwordx4 v[128:131], v44, s[52:55], s86 offen offset:2048 sc1
  s_waitcnt lgkmcnt(4)
  v_mfma_f32_16x16x32_bf16 a[236:239], a[112:115], a[156:159], 0
  v_cvt_pk_bf16_f32 v133, v218, v219
  v_cvt_pk_bf16_f32 v134, v220, v221
  v_mfma_f32_16x16x32_bf16 a[236:239], v[64:67], a[156:159], a[236:239]
  v_mfma_f32_16x16x32_bf16 a[236:239], a[116:119], a[152:155], a[236:239]
  v_cvt_pk_bf16_f32 v135, v222, v223
  v_pk_max_i16 v132, v132, 0
  v_mfma_f32_16x16x32_bf16 a[236:239], a[120:123], a[148:151], a[236:239]
  v_pk_max_i16 v133, v133, 0
  v_pk_max_i16 v134, v134, 0
  v_mfma_f32_16x16x32_bf16 a[236:239], a[124:127], a[144:147], a[236:239]
  v_pk_max_i16 v135, v135, 0
  s_waitcnt lgkmcnt(3)
  buffer_store_dwordx4 v[132:135], v44, s[52:55], s86 offen offset:2304 sc1
  v_mfma_f32_16x16x32_bf16 a[240:243], a[112:115], a[160:163], 0
  v_cvt_pk_bf16_f32 v136, v224, v225
  v_cvt_pk_bf16_f32 v137, v226, v227
  v_mfma_f32_16x16x32_bf16 a[240:243], v[64:67], a[160:163], a[240:243]
  v_mfma_f32_16x16x32_bf16 a[240:243], a[116:119], a[156:159], a[240:243]
  v_cvt_pk_bf16_f32 v138, v228, v229
  v_cvt_pk_bf16_f32 v139, v230, v231
  v_mfma_f32_16x16x32_bf16 a[240:243], a[120:123], a[152:155], a[240:243]
  v_pk_max_i16 v136, v136, 0
  v_pk_max_i16 v137, v137, 0
  v_mfma_f32_16x16x32_bf16 a[240:243], a[124:127], a[148:151], a[240:243]
  v_pk_max_i16 v138, v138, 0
  v_pk_max_i16 v139, v139, 0
  v_mfma_f32_16x16x32_bf16 a[240:243], a[128:131], a[144:147], a[240:243]
  v_cvt_pk_bf16_f32 v140, v232, v233
  buffer_store_dwordx4 v[136:139], v45, s[52:55], s86 offen offset:2048 sc1
  ds_read_b32 v76, v63
  s_waitcnt lgkmcnt(3)
  v_mfma_f32_16x16x32_bf16 a[244:247], a[112:115], a[164:167], 0
  v_cvt_pk_bf16_f32 v141, v234, v235
  v_cvt_pk_bf16_f32 v142, v236, v237
  ds_read_b128 v[176:179], v56 offset:64
  v_mfma_f32_16x16x32_bf16 a[244:247], v[64:67], a[164:167], a[244:247]
  v_mfma_f32_16x16x32_bf16 a[244:247], a[116:119], a[160:163], a[244:247]
  v_cvt_pk_bf16_f32 v143, v238, v239
  v_pk_max_i16 v140, v140, 0
  ds_read_b128 v[208:211], v57 offset:3648
  v_mfma_f32_16x16x32_bf16 a[244:247], a[120:123], a[156:159], a[244:247]
  v_pk_max_i16 v141, v141, 0
  v_pk_max_i16 v142, v142, 0
  ds_read_b128 v[180:183], v56 offset:576
  v_mfma_f32_16x16x32_bf16 a[244:247], a[124:127], a[152:155], a[244:247]
  v_pk_max_i16 v143, v143, 0
  ds_read_b128 v[212:215], v57 offset:3136
  buffer_store_dwordx4 v[140:143], v45, s[52:55], s86 offen offset:2304 sc1
  v_mfma_f32_16x16x32_bf16 a[244:247], a[128:131], a[148:151], a[244:247]
  ds_read_b128 v[184:187], v56 offset:1088
  v_mfma_f32_16x16x32_bf16 a[244:247], a[132:135], a[144:147], a[244:247]
  ds_read_b128 v[216:219], v57 offset:2624
  s_waitcnt lgkmcnt(8)
  v_mfma_f32_16x16x32_bf16 a[248:251], a[112:115], a[168:171], 0
  ds_read_b128 v[188:191], v56 offset:1600
  v_mfma_f32_16x16x32_bf16 a[248:251], v[64:67], a[168:171], a[248:251]
  v_mfma_f32_16x16x32_bf16 a[248:251], a[116:119], a[164:167], a[248:251]
  ds_read_b128 v[220:223], v57 offset:2112
  v_mfma_f32_16x16x32_bf16 a[248:251], a[120:123], a[160:163], a[248:251]
  ds_read_b128 v[192:195], v56 offset:2112
  v_mfma_f32_16x16x32_bf16 a[248:251], a[124:127], a[156:159], a[248:251]
  ds_read_b128 v[224:227], v57 offset:1600
  v_mfma_f32_16x16x32_bf16 a[248:251], a[128:131], a[152:155], a[248:251]
  ds_read_b128 v[196:199], v56 offset:2624
  ds_read_b32 v78, v63 offset:128
  v_mfma_f32_16x16x32_bf16 a[248:251], a[132:135], a[148:151], a[248:251]
  ds_read_b128 v[228:231], v57 offset:1088
  v_mfma_f32_16x16x32_bf16 a[248:251], a[136:139], a[144:147], a[248:251]
  ds_read_b128 v[200:203], v56 offset:3136
  s_waitcnt lgkmcnt(15)
  v_mfma_f32_16x16x32_bf16 a[252:255], a[112:115], a[172:175], 0
  ds_read_b128 v[232:235], v57 offset:576
  v_mfma_f32_16x16x32_bf16 a[252:255], v[64:67], a[172:175], a[252:255]
  v_mfma_f32_16x16x32_bf16 a[252:255], a[116:119], a[168:171], a[252:255]
  ds_read_b128 v[204:207], v56 offset:3648
  v_mfma_f32_16x16x32_bf16 a[252:255], a[120:123], a[164:167], a[252:255]
  ds_read_b128 v[236:239], v57 offset:64
  v_mfma_f32_16x16x32_bf16 a[252:255], a[124:127], a[160:163], a[252:255]
  v_mfma_f32_16x16x32_bf16 a[252:255], a[128:131], a[156:159], a[252:255]
  v_mfma_f32_16x16x32_bf16 a[252:255], a[132:135], a[152:155], a[252:255]
  v_mfma_f32_16x16x32_bf16 a[252:255], a[136:139], a[148:151], a[252:255]
  v_mfma_f32_16x16x32_bf16 a[252:255], a[140:143], a[144:147], a[252:255]
  s_waitcnt lgkmcnt(15)
  v_mfma_f32_16x16x32_bf16 a[224:227], v[176:179], v[208:211], a[224:227]
  s_waitcnt lgkmcnt(13)
  v_mfma_f32_16x16x32_bf16 a[228:231], v[176:179], v[212:215], a[228:231]
  v_mfma_f32_16x16x32_bf16 a[228:231], v[180:183], v[208:211], a[228:231]
  ds_read_b64_tr_b16 a[0:1], v50 offset:32768
  s_waitcnt lgkmcnt(12)
  v_mfma_f32_16x16x32_bf16 a[232:235], v[176:179], v[216:219], a[232:235]
  v_mfma_f32_16x16x32_bf16 a[232:235], v[180:183], v[212:215], a[232:235]
  ds_read_b128 a[112:115], v56 offset:128
  ds_read_b64_tr_b16 a[2:3], v50 offset:34816
  v_mfma_f32_16x16x32_bf16 a[232:235], v[184:187], v[208:211], a[232:235]
  ds_read_b128 a[144:147], v57 offset:3712
  s_waitcnt lgkmcnt(13)
  v_mfma_f32_16x16x32_bf16 a[236:239], v[176:179], v[220:223], a[236:239]
  ds_read_b64_tr_b16 a[4:5], v51 offset:32768
  v_mfma_f32_16x16x32_bf16 a[236:239], v[180:183], v[216:219], a[236:239]
  ds_read_b128 a[116:119], v56 offset:640
  v_mfma_f32_16x16x32_bf16 a[236:239], v[184:187], v[212:215], a[236:239]
  ds_read_b64_tr_b16 a[6:7], v51 offset:34816
  v_mfma_f32_16x16x32_bf16 a[236:239], v[188:191], v[208:211], a[236:239]
  ds_read_b128 a[148:151], v57 offset:3200
  s_waitcnt lgkmcnt(15)
  v_mfma_f32_16x16x32_bf16 a[240:243], v[176:179], v[224:227], a[240:243]
  ds_read_b64_tr_b16 a[8:9], v50 offset:33792
  v_mfma_f32_16x16x32_bf16 a[240:243], v[180:183], v[220:223], a[240:243]
  ds_read_b128 a[120:123], v56 offset:1152
  v_mfma_f32_16x16x32_bf16 a[240:243], v[184:187], v[216:219], a[240:243]
  ds_read_b128 a[152:155], v57 offset:2688
  ds_read_b64_tr_b16 a[10:11], v50 offset:35840
  v_mfma_f32_16x16x32_bf16 a[240:243], v[188:191], v[212:215], a[240:243]
  v_mfma_f32_16x16x32_bf16 a[240:243], v[192:195], v[208:211], a[240:243]
  ds_read_b128 a[124:127], v56 offset:1664
  ds_read_b64_tr_b16 a[12:13], v51 offset:33792
  s_waitcnt lgkmcnt(15)
  v_and_b32 v77, 0xffff0000, v76
  v_and_b32 v79, 0xffff0000, v78
  v_lshlrev_b32 v76, 16, v76
  v_lshlrev_b32 v78, 16, v78
  v_rcp_f32 v77, v77
  v_rcp_f32 v79, v79
  v_lshlrev_b32 v24, 16, v104
  v_and_b32 v25, 0xffff0000, v104
  v_lshlrev_b32 v26, 16, v105
  v_and_b32 v27, 0xffff0000, v105
  v_lshlrev_b32 v28, 16, v106
  v_and_b32 v29, 0xffff0000, v106
  v_lshlrev_b32 v30, 16, v107
  v_and_b32 v31, 0xffff0000, v107
  v_lshlrev_b32 v32, 16, v108
  v_and_b32 v33, 0xffff0000, v108
  v_lshlrev_b32 v34, 16, v109
  v_and_b32 v35, 0xffff0000, v109
  v_lshlrev_b32 v36, 16, v110
  v_and_b32 v37, 0xffff0000, v110
  v_lshlrev_b32 v38, 16, v111
  v_and_b32 v39, 0xffff0000, v111
  v_pk_add_f32 v[240:241], v[24:25], v[76:77] op_sel_hi:[1,0]
  v_pk_add_f32 v[242:243], v[26:27], v[76:77] op_sel_hi:[1,0]
  v_pk_add_f32 v[244:245], v[28:29], v[76:77] op_sel_hi:[1,0]
  v_pk_add_f32 v[246:247], v[30:31], v[76:77] op_sel_hi:[1,0]
  v_pk_add_f32 v[248:249], v[32:33], v[78:79] op_sel_hi:[1,0]
  v_pk_add_f32 v[250:251], v[34:35], v[78:79] op_sel_hi:[1,0]
  v_pk_add_f32 v[252:253], v[36:37], v[78:79] op_sel_hi:[1,0]
  v_pk_add_f32 v[254:255], v[38:39], v[78:79] op_sel_hi:[1,0]
  v_and_b32 v1, 31, v0
  v_lshlrev_b32 v1, 8, v1
  v_add_u32 v1, s67, v1
  v_xor_b32 v2, v7, v9
  v_xor_b32 v3, 0, v2
  v_lshl_add_u32 v71, v3, 4, v1
  v_xor_b32 v3, 2, v2
  v_lshl_add_u32 v80, v3, 4, v1
  v_xor_b32 v3, 4, v2
  v_lshl_add_u32 v81, v3, 4, v1
  v_xor_b32 v3, 6, v2
  v_lshl_add_u32 v82, v3, 4, v1
  v_lshlrev_b32 v1, 1, v7
  v_xor_b32 v1, v1, v6
  v_lshlrev_b32 v2, 8, v11
  v_lshl_add_u32 v83, v1, 4, v2
  v_xor_b32 v84, 16, v83
  s_mul_i32 s70, s60, 1040
  s_add_u32 s70, s70, 131840
  v_add_u32 v85, s70, v10
  v_mul_u32_u24 v1, 1040, v7
  v_lshl_add_u32 v1, v11, 2, v1
  v_add_u32 v89, 131840, v1
  v_mov_b32 v95, s100
  v_mov_b32 v99, s100
  v_mov_b32 v103, s100
  s_add_u32 s73, s90, 28672
  s_waitcnt vmcnt(0)
  s_atomic_swap s100, s[26:27], s83
  s_atomic_swap s100, s[26:27], s84
  s_add_u32 m0, s67, 65536
  s_nop 0
  buffer_load_dwordx4 v46, s[44:47], s89 offen offset:0 lds
  buffer_load_dwordx4 v47, s[44:47], s89 offen offset:1024 lds
  v_mfma_f32_16x16x32_bf16 a[244:247], v[176:179], v[228:231], a[244:247]
  v_mfma_f32_16x16x32_bf16 a[244:247], v[180:183], v[224:227], a[244:247]
  buffer_load_dwordx4 v48, s[44:47], s89 offen offset:2048 lds
  ds_read_b128 a[156:159], v57 offset:2176
  ds_read_b64_tr_b16 a[14:15], v51 offset:35840
  v_mfma_f32_16x16x32_bf16 a[244:247], v[184:187], v[220:223], a[244:247]
  v_mfma_f32_16x16x32_bf16 a[244:247], v[188:191], v[216:219], a[244:247]
  buffer_load_dwordx4 v49, s[44:47], s89 offen offset:3072 lds
  s_add_u32 s89, s89, 28672
  ds_read_b128 a[128:131], v56 offset:2176
  v_mfma_f32_16x16x32_bf16 a[244:247], v[192:195], v[212:215], a[244:247]
  ds_read_b128 a[160:163], v57 offset:1664
  v_mfma_f32_16x16x32_bf16 a[244:247], v[196:199], v[208:211], a[244:247]
  ds_read_b64_tr_b16 a[16:17], v50 offset:36864
  s_add_u32 m0, s67, 69632
  s_nop 0
  buffer_load_dwordx4 v46, s[44:47], s89 offen offset:0 lds
  v_mfma_f32_16x16x32_bf16 a[248:251], v[176:179], v[232:235], a[248:251]
  ds_read_b128 a[132:135], v56 offset:2688
  v_mfma_f32_16x16x32_bf16 a[248:251], v[180:183], v[228:231], a[248:251]
  ds_read_b64_tr_b16 a[18:19], v50 offset:38912
  v_mfma_f32_16x16x32_bf16 a[248:251], v[184:187], v[224:227], a[248:251]
  buffer_load_dwordx4 v47, s[44:47], s89 offen offset:1024 lds
  ds_read_b128 a[164:167], v57 offset:1152
  v_mfma_f32_16x16x32_bf16 a[248:251], v[188:191], v[220:223], a[248:251]
  ds_read_b64_tr_b16 a[20:21], v51 offset:36864
  v_mfma_f32_16x16x32_bf16 a[248:251], v[192:195], v[216:219], a[248:251]
  ds_read_b128 a[136:139], v56 offset:3200
  v_mfma_f32_16x16x32_bf16 a[248:251], v[196:199], v[212:215], a[248:251]
  buffer_load_dwordx4 v48, s[44:47], s89 offen offset:2048 lds
  ds_read_b128 a[168:171], v57 offset:640
  ds_read_b64_tr_b16 a[22:23], v51 offset:38912
  v_mfma_f32_16x16x32_bf16 a[248:251], v[200:203], v[208:211], a[248:251]
  s_waitcnt lgkmcnt(15)
  v_mfma_f32_16x16x32_bf16 a[252:255], v[176:179], v[236:239], a[252:255]
  ds_read_b128 a[140:143], v56 offset:3712
  buffer_load_dwordx4 v49, s[44:47], s89 offen offset:3072 lds
  s_add_u32 s89, s89, 28672
  ds_read_b64_tr_b16 a[24:25], v50 offset:37888
  v_mfma_f32_16x16x32_bf16 a[252:255], v[180:183], v[232:235], a[252:255]
  v_mfma_f32_16x16x32_bf16 a[252:255], v[184:187], v[228:231], a[252:255]
  ds_read_b128 a[172:175], v57 offset:128
  s_mov_b32 m0, s67
  ds_read_b64_tr_b16 a[26:27], v50 offset:39936
  buffer_load_dwordx4 v46, s[44:47], s89 offen offset:0 lds
  v_mfma_f32_16x16x32_bf16 a[252:255], v[188:191], v[224:227], a[252:255]
  v_mfma_f32_16x16x32_bf16 a[252:255], v[192:195], v[220:223], a[252:255]
  ds_read_b64_tr_b16 a[28:29], v51 offset:37888
  v_mfma_f32_16x16x32_bf16 a[252:255], v[196:199], v[216:219], a[252:255]
  buffer_load_dwordx4 v47, s[44:47], s89 offen offset:1024 lds
  v_mfma_f32_16x16x32_bf16 a[252:255], v[200:203], v[212:215], a[252:255]
  ds_read_b64_tr_b16 a[30:31], v51 offset:39936
  v_mfma_f32_16x16x32_bf16 a[252:255], v[204:207], v[208:211], a[252:255]
  v_mfma_f32_16x16x32_bf16 a[224:227], a[112:115], a[144:147], a[224:227]
  buffer_load_dwordx4 v48, s[44:47], s89 offen offset:2048 lds
  v_mfma_f32_16x16x32_bf16 a[228:231], a[112:115], a[148:151], a[228:231]
  v_mfma_f32_16x16x32_bf16 a[228:231], a[116:119], a[144:147], a[228:231]
  v_mfma_f32_16x16x32_bf16 a[232:235], a[112:115], a[152:155], a[232:235]
  buffer_load_dwordx4 v49, s[44:47], s89 offen offset:3072 lds
  s_add_u32 s89, s89, 28672
  v_mfma_f32_16x16x32_bf16 a[232:235], a[116:119], a[148:151], a[232:235]
  ds_read_b128 v[176:179], v56 offset:192
  v_mfma_f32_16x16x32_bf16 a[232:235], a[120:123], a[144:147], a[232:235]
  ds_read_b128 v[208:211], v57 offset:3776
  s_waitcnt lgkmcnt(15)
  s_add_u32 m0, s67, 4096
  v_mfma_f32_16x16x32_bf16 a[236:239], a[112:115], a[156:159], a[236:239]
  buffer_load_dwordx4 v46, s[44:47], s89 offen offset:0 lds
  v_mfma_f32_16x16x32_bf16 a[236:239], a[116:119], a[152:155], a[236:239]
  ds_read_b128 v[180:183], v56 offset:704
  v_mfma_f32_16x16x32_bf16 a[236:239], a[120:123], a[148:151], a[236:239]
  v_mfma_f32_16x16x32_bf16 a[236:239], a[124:127], a[144:147], a[236:239]
  buffer_load_dwordx4 v47, s[44:47], s89 offen offset:1024 lds
  ds_read_b128 v[212:215], v57 offset:3264
  v_mfma_f32_16x16x32_bf16 a[240:243], a[112:115], a[160:163], a[240:243]
  v_mfma_f32_16x16x32_bf16 a[240:243], a[116:119], a[156:159], a[240:243]
  ds_read_b128 v[184:187], v56 offset:1216
  buffer_load_dwordx4 v48, s[44:47], s89 offen offset:2048 lds
  v_mfma_f32_16x16x32_bf16 a[240:243], a[120:123], a[152:155], a[240:243]
  ds_read_b128 v[216:219], v57 offset:2752
  v_mfma_f32_16x16x32_bf16 a[240:243], a[124:127], a[148:151], a[240:243]
  v_mfma_f32_16x16x32_bf16 a[240:243], a[128:131], a[144:147], a[240:243]
  buffer_load_dwordx4 v49, s[44:47], s89 offen offset:3072 lds
  s_add_u32 s89, s89, 28672
  s_waitcnt vmcnt(12)
  ds_read_b128 v[188:191], v56 offset:1728
  ds_read_b64_tr_b16 a[32:33], v52 offset:0
  s_waitcnt lgkmcnt(15)
  ds_read_b64_tr_b16 a[34:35], v52 offset:2048
  v_mfma_f32_16x16x32_bf16 a[244:247], a[112:115], a[164:167], a[244:247]
  ds_read_b64_tr_b16 a[36:37], v53 offset:0
  ds_read_b64_tr_b16 a[38:39], v53 offset:2048
  v_mfma_f32_16x16x32_bf16 a[244:247], a[116:119], a[160:163], a[244:247]
  ds_read_b64_tr_b16 a[40:41], v52 offset:1024
  ds_read_b64_tr_b16 a[42:43], v52 offset:3072
  ds_read_b128 v[220:223], v57 offset:2240
  ds_read_b64_tr_b16 a[44:45], v53 offset:1024
  ds_read_b64_tr_b16 a[46:47], v53 offset:3072
  v_mfma_f32_16x16x32_bf16 a[244:247], a[120:123], a[156:159], a[244:247]
  ds_read_b32 v5, v40
  ds_read_b32 v5, v40
  s_waitcnt lgkmcnt(2)
  s_add_u32 m0, s67, 65536
  s_nop 0
  buffer_load_dwordx4 v46, s[44:47], s89 offen offset:0 lds
  v_mfma_f32_16x16x32_bf16 a[244:247], a[124:127], a[152:155], a[244:247]
  buffer_load_dwordx4 v47, s[44:47], s89 offen offset:1024 lds
  ds_read_b128 v[192:195], v56 offset:2240
  v_mfma_f32_16x16x32_bf16 a[244:247], a[128:131], a[148:151], a[244:247]
  ds_read_b128 v[224:227], v57 offset:1728
  v_mfma_f32_16x16x32_bf16 a[244:247], a[132:135], a[144:147], a[244:247]
  v_mfma_f32_16x16x32_bf16 a[248:251], a[112:115], a[168:171], a[248:251]
  buffer_load_dwordx4 v48, s[44:47], s89 offen offset:2048 lds
  ds_read_b128 v[196:199], v56 offset:2752
  v_mfma_f32_16x16x32_bf16 a[248:251], a[116:119], a[164:167], a[248:251]
  v_mfma_f32_16x16x32_bf16 a[248:251], a[120:123], a[160:163], a[248:251]
  ds_read_b128 v[228:231], v57 offset:1216
  buffer_load_dwordx4 v49, s[44:47], s89 offen offset:3072 lds
  v_mfma_f32_16x16x32_bf16 a[248:251], a[124:127], a[156:159], a[248:251]
  v_mfma_f32_16x16x32_bf16 a[248:251], a[128:131], a[152:155], a[248:251]
  ds_read_b128 v[200:203], v56 offset:3264
  v_mfma_f32_16x16x32_bf16 a[248:251], a[132:135], a[148:151], a[248:251]
  ds_read_b128 v[232:235], v57 offset:704
  v_mfma_f32_16x16x32_bf16 a[248:251], a[136:139], a[144:147], a[248:251]
  v_mfma_f32_16x16x32_bf16 a[252:255], a[112:115], a[172:175], a[252:255]
  ds_read_b128 v[204:207], v56 offset:3776
  v_mfma_f32_16x16x32_bf16 a[252:255], a[116:119], a[168:171], a[252:255]
  v_mfma_f32_16x16x32_bf16 a[252:255], a[120:123], a[164:167], a[252:255]
  ds_read_b128 v[236:239], v57 offset:192
  s_load_dwordx8 s[92:99], s[26:27], s85 glc
  v_mfma_f32_16x16x32_bf16 a[252:255], a[124:127], a[160:163], a[252:255]
  v_mfma_f32_16x16x32_bf16 a[252:255], a[128:131], a[156:159], a[252:255]
  v_mfma_f32_16x16x32_bf16 a[252:255], a[132:135], a[152:155], a[252:255]
  v_mfma_f32_16x16x32_bf16 a[252:255], a[136:139], a[148:151], a[252:255]
  v_mfma_f32_16x16x32_bf16 a[252:255], a[140:143], a[144:147], a[252:255]
  v_mfma_f32_16x16x32_bf16 a[224:227], v[176:179], v[208:211], a[224:227]
  v_mfma_f32_16x16x32_bf16 a[228:231], v[176:179], v[212:215], a[228:231]
  v_mfma_f32_16x16x32_bf16 a[228:231], v[180:183], v[208:211], a[228:231]
  v_mfma_f32_16x16x32_bf16 a[232:235], v[176:179], v[216:219], a[232:235]
  v_mfma_f32_16x16x32_bf16 a[232:235], v[180:183], v[212:215], a[232:235]
  v_mfma_f32_16x16x32_bf16 a[232:235], v[184:187], v[208:211], a[232:235]
  v_mfma_f32_16x16x32_bf16 a[236:239], v[176:179], v[220:223], a[236:239]
  ds_write_b128 v86, a[224:227] offset:0
  v_mfma_f32_16x16x32_bf16 a[236:239], v[180:183], v[216:219], a[236:239]
  v_mfma_f32_16x16x32_bf16 a[236:239], v[184:187], v[212:215], a[236:239]
  v_mfma_f32_16x16x32_bf16 a[236:239], v[188:191], v[208:211], a[236:239]
  s_waitcnt lgkmcnt(7)
  v_mfma_f32_16x16x32_bf16 a[240:243], v[176:179], v[224:227], a[240:243]
  ds_write_b128 v86, a[228:231] offset:1024
  v_mfma_f32_16x16x32_bf16 a[240:243], v[180:183], v[220:223], a[240:243]
  v_mfma_f32_16x16x32_bf16 a[240:243], v[184:187], v[216:219], a[240:243]
  s_waitcnt lgkmcnt(0)
  s_xor_b64 s[92:93], s[92:93], s[100:101]
  s_xor_b64 s[94:95], s[94:95], s[100:101]
  v_mfma_f32_16x16x32_bf16 a[240:243], v[188:191], v[212:215], a[240:243]
  s_xor_b64 s[96:97], s[96:97], s[100:101]
  s_xor_b64 s[98:99], s[98:99], s[100:101]
  v_mfma_f32_16x16x32_bf16 a[240:243], v[192:195], v[208:211], a[240:243]
  ds_write_b128 v86, a[232:235] offset:2048
  s_or_b64 s[92:93], s[92:93], s[94:95]
  s_or_b64 s[96:97], s[96:97], s[98:99]
  v_mfma_f32_16x16x32_bf16 a[244:247], v[176:179], v[228:231], a[244:247]
  s_or_b64 s[92:93], s[92:93], s[96:97]
  s_cbranch_scc1 RETRY3
OK3:
  v_mfma_f32_16x16x32_bf16 a[244:247], v[180:183], v[224:227], a[244:247]
  buffer_load_dwordx4 v[112:115], v10, s[52:55], s87 offen offset:0 sc1
  buffer_load_dwordx4 v[116:119], v10, s[52:55], s87 offen offset:1024 sc1
  v_mfma_f32_16x16x32_bf16 a[244:247], v[184:187], v[220:223], a[244:247]
  buffer_load_dwordx4 v[120:123], v10, s[52:55], s87 offen offset:2048 sc1
  v_mfma_f32_16x16x32_bf16 a[244:247], v[188:191], v[216:219], a[244:247]
  s_waitcnt vmcnt(15)
  ds_write_b128 v86, a[236:239] offset:3072
  buffer_load_dwordx4 v[124:127], v10, s[52:55], s87 offen offset:3072 sc1
PG3:
  s_cbranch_execz PGBACK
  s_add_u32 s87, s87, 4096
  v_mfma_f32_16x16x32_bf16 a[244:247], v[192:195], v[212:215], a[244:247]
  ds_read_b64_tr_b16 a[48:49], v52 offset:4096
  v_mfma_f32_16x16x32_bf16 a[244:247], v[196:199], v[208:211], a[244:247]
  buffer_load_dwordx4 v[128:131], v10, s[52:55], s87 offen offset:0 sc1
  ds_read_b64_tr_b16 a[50:51], v52 offset:6144
  v_mfma_f32_16x16x32_bf16 a[248:251], v[176:179], v[232:235], a[248:251]
  ds_read_b64_tr_b16 a[52:53], v53 offset:4096
  v_mfma_f32_16x16x32_bf16 a[248:251], v[180:183], v[228:231], a[248:251]
  buffer_load_dwordx4 v[132:135], v10, s[52:55], s87 offen offset:1024 sc1
  ds_read_b64_tr_b16 a[54:55], v53 offset:6144
  ds_write_b128 v86, a[240:243] offset:4096
  v_mfma_f32_16x16x32_bf16 a[248:251], v[184:187], v[224:227], a[248:251]
  ds_read_b64_tr_b16 a[56:57], v52 offset:5120
  buffer_load_dwordx4 v[136:139], v10, s[52:55], s87 offen offset:2048 sc1
  v_mfma_f32_16x16x32_bf16 a[248:251], v[188:191], v[220:223], a[248:251]
  ds_read_b64_tr_b16 a[58:59], v52 offset:7168
  v_mfma_f32_16x16x32_bf16 a[248:251], v[192:195], v[216:219], a[248:251]
  ds_read_b64_tr_b16 a[60:61], v53 offset:5120
  v_mfma_f32_16x16x32_bf16 a[248:251], v[196:199], v[212:215], a[248:251]
  buffer_load_dwordx4 v[140:143], v10, s[52:55], s87 offen offset:3072 sc1
  s_add_u32 s87, s87, 4096
  ds_read_b64_tr_b16 a[62:63], v53 offset:7168
  ds_write_b128 v86, a[244:247] offset:5120
  buffer_load_dwordx4 v[144:147], v10, s[52:55], s87 offen offset:0 sc1
  v_mfma_f32_16x16x32_bf16 a[248:251], v[200:203], v[208:211], a[248:251]
  s_waitcnt vmcnt(17)
  v_mfma_f32_16x16x32_bf16 a[252:255], v[176:179], v[236:239], a[252:255]
  ds_read_b64_tr_b16 a[64:65], v50 offset:0
  v_mfma_f32_16x16x32_bf16 a[252:255], v[180:183], v[232:235], a[252:255]
  buffer_load_dwordx4 v[148:151], v10, s[52:55], s87 offen offset:1024 sc1
  ds_read_b64_tr_b16 a[66:67], v50 offset:2048
  v_mfma_f32_16x16x32_bf16 a[252:255], v[184:187], v[228:231], a[252:255]
  ds_read_b64_tr_b16 a[68:69], v51 offset:0
  v_mfma_f32_16x16x32_bf16 a[252:255], v[188:191], v[224:227], a[252:255]
  ds_read_b64_tr_b16 a[70:71], v51 offset:2048
  ds_write_b128 v86, a[248:251] offset:6144
  v_mfma_f32_16x16x32_bf16 a[252:255], v[192:195], v[220:223], a[252:255]
  ds_read_b64_tr_b16 a[72:73], v50 offset:1024
  v_mfma_f32_16x16x32_bf16 a[252:255], v[196:199], v[216:219], a[252:255]
  ds_read_b64_tr_b16 a[74:75], v50 offset:3072
  v_mfma_f32_16x16x32_bf16 a[252:255], v[200:203], v[212:215], a[252:255]
  ds_read_b64_tr_b16 a[76:77], v51 offset:1024
  v_mfma_f32_16x16x32_bf16 a[252:255], v[204:207], v[208:211], a[252:255]
  ds_read_b64_tr_b16 a[78:79], v51 offset:3072
  s_nop 6
  ds_write_b128 v86, a[252:255] offset:7168
  s_waitcnt vmcnt(9)
  v_mfma_f32_32x32x16_bf16 a[112:127], a[0:3], v[112:115], 0
  ds_read_b64_tr_b16 a[80:81], v50 offset:4096
  v_mfma_f32_32x32x16_bf16 a[128:143], a[4:7], v[112:115], 0
  ds_read_b64_tr_b16 a[82:83], v50 offset:6144
  s_waitcnt lgkmcnt(2)
  s_barrier
  ds_read_b128 v[176:179], v87 offset:0
  ds_read_b128 v[180:183], v87 offset:8192
  buffer_load_dwordx4 v[152:155], v10, s[52:55], s87 offen offset:2048 sc1
  buffer_load_dwordx4 v[156:159], v10, s[52:55], s87 offen offset:3072 sc1
  s_add_u32 s87, s87, 4096
  s_waitcnt vmcnt(10)
  v_mfma_f32_32x32x16_bf16 a[112:127], a[8:11], v[116:119], a[112:127]
  ds_read_b64_tr_b16 a[84:85], v51 offset:4096
  ds_read_b128 v[184:187], v87 offset:16384
  ds_read_b128 v[188:191], v87 offset:24576
  v_mfma_f32_32x32x16_bf16 a[128:143], a[12:15], v[116:119], a[128:143]
  ds_read_b64_tr_b16 a[86:87], v51 offset:6144
  ds_read_b64_tr_b16 a[88:89], v50 offset:5120
  ds_read_b128 v[192:195], v87 offset:16
  ds_read_b128 v[196:199], v87 offset:8208
  buffer_load_dwordx4 v[160:163], v10, s[52:55], s87 offen offset:0 sc1
  buffer_load_dwordx4 v[164:167], v10, s[52:55], s87 offen offset:1024 sc1
  s_add_u32 s87, s87, 45056
  s_waitcnt vmcnt(11)
  v_mfma_f32_32x32x16_bf16 a[112:127], a[16:19], v[120:123], a[112:127]
  ds_read_b64_tr_b16 a[90:91], v50 offset:7168
  ds_read_b128 v[200:203], v87 offset:16400
  ds_read_b128 v[204:207], v87 offset:24592
  v_mfma_f32_32x32x16_bf16 a[128:143], a[20:23], v[120:123], a[128:143]
  ds_read_b64_tr_b16 a[92:93], v51 offset:5120
  buffer_load_dwordx4 v[168:171], v10, s[52:55], s87 offen offset:0 sc1
  buffer_load_dwordx4 v[172:175], v10, s[52:55], s87 offen offset:1024 sc1
  s_waitcnt vmcnt(12)
  v_mfma_f32_32x32x16_bf16 a[112:127], a[24:27], v[124:127], a[112:127]
  ds_read_b64_tr_b16 a[94:95], v51 offset:7168
  v_mfma_f32_32x32x16_bf16 a[128:143], a[28:31], v[124:127], a[128:143]
  ds_read_b64_tr_b16 a[96:97], v52 offset:0
  buffer_load_dwordx4 v[112:115], v10, s[52:55], s87 offen offset:2048 sc1
  buffer_load_dwordx4 v[116:119], v10, s[52:55], s87 offen offset:3072 sc1
  s_add_u32 s87, s87, 4096
  s_waitcnt vmcnt(13)
  v_mfma_f32_32x32x16_bf16 a[112:127], a[32:35], v[128:131], a[112:127]
  ds_read_b64_tr_b16 a[98:99], v52 offset:2048
  v_mfma_f32_32x32x16_bf16 a[128:143], a[36:39], v[128:131], a[128:143]
  ds_read_b64_tr_b16 a[100:101], v53 offset:0
  s_waitcnt lgkmcnt(12)
  v_add_f32 v176, v176, v180
  v_add_f32 v184, v184, v188
  v_cvt_pk_bf16_f32 v16, v176, v184
  v_add_f32 v177, v177, v181
  v_add_f32 v185, v185, v189
  buffer_load_dwordx4 v[120:123], v10, s[52:55], s87 offen offset:0 sc1
  buffer_load_dwordx4 v[124:127], v10, s[52:55], s87 offen offset:1024 sc1
  s_waitcnt vmcnt(14)
  v_mfma_f32_32x32x16_bf16 a[112:127], a[40:43], v[132:135], a[112:127]
  ds_read_b64_tr_b16 a[102:103], v53 offset:2048
  ds_read_b64_tr_b16 a[104:105], v52 offset:1024
  v_cvt_pk_bf16_f32 v17, v177, v185
  v_add_f32 v178, v178, v182
  v_add_f32 v186, v186, v190
  v_cvt_pk_bf16_f32 v18, v178, v186
  v_add_f32 v179, v179, v183
  v_mfma_f32_32x32x16_bf16 a[128:143], a[44:47], v[132:135], a[128:143]
  ds_read_b64_tr_b16 a[106:107], v52 offset:3072
  v_add_f32 v187, v187, v191
  v_cvt_pk_bf16_f32 v19, v179, v187
  s_waitcnt lgkmcnt(8)
  v_add_f32 v192, v192, v196
  v_add_f32 v200, v200, v204
  buffer_load_dwordx4 v[128:131], v10, s[52:55], s87 offen offset:2048 sc1
  s_waitcnt vmcnt(14)
  v_mfma_f32_32x32x16_bf16 a[112:127], a[48:51], v[136:139], a[112:127]
  ds_read_b64_tr_b16 a[108:109], v53 offset:1024
  v_cvt_pk_bf16_f32 v20, v192, v200
  v_add_f32 v193, v193, v197
  v_add_f32 v201, v201, v205
  v_cvt_pk_bf16_f32 v21, v193, v201
  v_add_f32 v194, v194, v198
  v_mfma_f32_32x32x16_bf16 a[128:143], a[52:55], v[136:139], a[128:143]
  ds_read_b64_tr_b16 a[110:111], v53 offset:3072
  v_add_f32 v202, v202, v206
  v_cvt_pk_bf16_f32 v22, v194, v202
  v_add_f32 v195, v195, v199
  v_add_f32 v203, v203, v207
  v_cvt_pk_bf16_f32 v23, v195, v203
  buffer_load_dwordx4 v[132:135], v10, s[52:55], s87 offen offset:3072 sc1
  s_add_u32 s87, s87, 4096
  s_waitcnt vmcnt(14)
  v_mfma_f32_32x32x16_bf16 a[112:127], a[56:59], v[140:143], a[112:127]
  buffer_store_dwordx4 v[16:19], v88, s[52:55], s32 offen offset:0 sc1
  v_mfma_f32_32x32x16_bf16 a[128:143], a[60:63], v[140:143], a[128:143]
  buffer_store_dwordx4 v[20:23], v88, s[52:55], s32 offen offset:128 sc1
  buffer_load_dwordx4 v[136:139], v10, s[52:55], s87 offen offset:0 sc1
  s_waitcnt vmcnt(16)
  v_mfma_f32_32x32x16_bf16 a[112:127], a[64:67], v[144:147], a[112:127]
  v_mfma_f32_32x32x16_bf16 a[128:143], a[68:71], v[144:147], a[128:143]
  buffer_load_dwordx4 v[140:143], v10, s[52:55], s87 offen offset:1024 sc1
  s_waitcnt vmcnt(16)
  v_mfma_f32_32x32x16_bf16 a[112:127], a[72:75], v[148:151], a[112:127]
  v_mfma_f32_32x32x16_bf16 a[128:143], a[76:79], v[148:151], a[128:143]
  buffer_load_dwordx4 v[144:147], v10, s[52:55], s87 offen offset:2048 sc1
  s_waitcnt vmcnt(16) lgkmcnt(8)
  v_mfma_f32_32x32x16_bf16 a[112:127], a[80:83], v[152:155], a[112:127]
  v_mfma_f32_32x32x16_bf16 a[128:143], a[84:87], v[152:155], a[128:143]
  buffer_load_dwordx4 v[148:151], v10, s[52:55], s87 offen offset:3072 sc1
  s_add_u32 s87, s87, 4096
  s_waitcnt vmcnt(16)
  v_mfma_f32_32x32x16_bf16 a[112:127], a[88:91], v[156:159], a[112:127]
  v_mfma_f32_32x32x16_bf16 a[128:143], a[92:95], v[156:159], a[128:143]
  buffer_load_dwordx4 v[152:155], v10, s[52:55], s87 offen offset:0 sc1
  s_waitcnt vmcnt(16) lgkmcnt(0)
  v_mfma_f32_32x32x16_bf16 a[112:127], a[96:99], v[160:163], a[112:127]
  v_mfma_f32_32x32x16_bf16 a[128:143], a[100:103], v[160:163], a[128:143]
  buffer_load_dwordx4 v[156:159], v10, s[52:55], s87 offen offset:1024 sc1
  s_mov_b32 s87, s88
  s_waitcnt vmcnt(16)
  v_mfma_f32_32x32x16_bf16 a[112:127], a[104:107], v[164:167], a[112:127]
  v_mfma_f32_32x32x16_bf16 a[128:143], a[108:111], v[164:167], a[128:143]
  buffer_load_dwordx4 v[160:163], v10, s[52:55], s87 offen offset:0 sc1
  s_waitcnt vmcnt(16)
  v_mfma_f32_32x32x16_bf16 a[144:159], a[0:3], v[168:171], 0
  v_mfma_f32_32x32x16_bf16 a[160:175], a[4:7], v[168:171], 0
  buffer_load_dwordx4 v[164:167], v10, s[52:55], s87 offen offset:1024 sc1
  s_waitcnt vmcnt(16)
  v_mfma_f32_32x32x16_bf16 a[144:159], a[8:11], v[172:175], a[144:159]
  ds_write_b128 v71, a[112:115] offset:0
  v_mfma_f32_32x32x16_bf16 a[160:175], a[12:15], v[172:175], a[160:175]
  ds_write_b128 v80, a[116:119] offset:0
  buffer_load_dwordx4 v[168:171], v10, s[52:55], s87 offen offset:2048 sc1
  s_waitcnt vmcnt(16)
  v_mfma_f32_32x32x16_bf16 a[144:159], a[16:19], v[112:115], a[144:159]
  v_mfma_f32_32x32x16_bf16 a[160:175], a[20:23], v[112:115], a[160:175]
  ds_write_b128 v81, a[120:123] offset:0
  buffer_load_dwordx4 v[172:175], v10, s[52:55], s87 offen offset:3072 sc1
  s_add_u32 s87, s87, 4096
  s_waitcnt vmcnt(16)
  v_mfma_f32_32x32x16_bf16 a[144:159], a[24:27], v[116:119], a[144:159]
  s_waitcnt vmcnt(10)
  s_atomic_swap s100, s[26:27], s36
  ds_write_b128 v82, a[124:127] offset:0
  v_mfma_f32_32x32x16_bf16 a[160:175], a[28:31], v[116:119], a[160:175]
  buffer_load_dwordx4 v[112:115], v10, s[52:55], s87 offen offset:0 sc1
  v_mfma_f32_32x32x16_bf16 a[144:159], a[32:35], v[120:123], a[144:159]
  ds_write_b128 v71, a[128:131] offset:128
  v_mfma_f32_32x32x16_bf16 a[160:175], a[36:39], v[120:123], a[160:175]
  ds_write_b128 v80, a[132:135] offset:128
  buffer_load_dwordx4 v[116:119], v10, s[52:55], s87 offen offset:1024 sc1
  v_mfma_f32_32x32x16_bf16 a[144:159], a[40:43], v[124:127], a[144:159]
  v_mfma_f32_32x32x16_bf16 a[160:175], a[44:47], v[124:127], a[160:175]
  ds_write_b128 v81, a[136:139] offset:128
  buffer_load_dwordx4 v[120:123], v10, s[52:55], s87 offen offset:2048 sc1
  v_mfma_f32_32x32x16_bf16 a[144:159], a[48:51], v[128:131], a[144:159]
  ds_write_b128 v82, a[140:143] offset:128
  v_mfma_f32_32x32x16_bf16 a[160:175], a[52:55], v[128:131], a[160:175]
  buffer_load_dwordx4 v[124:127], v10, s[52:55], s87 offen offset:3072 sc1
  s_add_u32 s87, s87, 4096
  v_mfma_f32_32x32x16_bf16 a[144:159], a[56:59], v[132:135], a[144:159]
  v_mfma_f32_32x32x16_bf16 a[160:175], a[60:63], v[132:135], a[160:175]
  buffer_load_dwordx4 v[128:131], v10, s[52:55], s87 offen offset:0 sc1
  s_waitcnt vmcnt(14)
  v_mfma_f32_32x32x16_bf16 a[144:159], a[64:67], v[136:139], a[144:159]
  ds_read_b32 v5, v40
  s_waitcnt lgkmcnt(1)
  s_barrier
  ds_read_b128 v[208:211], v83 offset:0
  ds_read_b128 v[212:215], v84 offset:0
  v_mfma_f32_32x32x16_bf16 a[160:175], a[68:71], v[136:139], a[160:175]
  ds_read_b128 v[216:219], v83 offset:8192
  ds_read_b128 v[220:223], v84 offset:8192
  buffer_load_dwordx4 v[132:135], v10, s[52:55], s87 offen offset:1024 sc1
  s_waitcnt vmcnt(14)
  v_mfma_f32_32x32x16_bf16 a[144:159], a[72:75], v[140:143], a[144:159]
  ds_read_b128 v[224:227], v83 offset:16384
  ds_read_b128 v[228:231], v84 offset:16384
  v_mfma_f32_32x32x16_bf16 a[160:175], a[76:79], v[140:143], a[160:175]
  ds_read_b128 v[232:235], v83 offset:24576
  ds_read_b128 v[236:239], v84 offset:24576
  buffer_load_dwordx4 v[136:139], v10, s[52:55], s87 offen offset:2048 sc1
  s_waitcnt vmcnt(14)
  v_mfma_f32_32x32x16_bf16 a[144:159], a[80:83], v[144:147], a[144:159]
  v_mfma_f32_32x32x16_bf16 a[160:175], a[84:87], v[144:147], a[160:175]
  buffer_load_dwordx4 v[140:143], v10, s[52:55], s87 offen offset:3072 sc1
  s_add_u32 s87, s87, 4096
  s_waitcnt vmcnt(14)
  v_mfma_f32_32x32x16_bf16 a[144:159], a[88:91], v[148:151], a[144:159]
  ds_read_b32 v5, v40
  s_waitcnt lgkmcnt(1)
  v_add_f32 v208, v208, v216
  v_add_f32 v224, v224, v232
  v_add_f32 v208, v208, v224
  v_mfma_f32_32x32x16_bf16 a[160:175], a[92:95], v[148:151], a[160:175]
  v_add_f32 v209, v209, v217
  v_add_f32 v225, v225, v233
  v_add_f32 v209, v209, v225
  v_cvt_pk_bf16_f32 v92, v208, v209
  buffer_load_dwordx4 v[144:147], v10, s[52:55], s87 offen offset:0 sc1
  s_waitcnt vmcnt(14)
  v_mfma_f32_32x32x16_bf16 a[144:159], a[96:99], v[152:155], a[144:159]
  v_add_f32 v210, v210, v218
  v_add_f32 v226, v226, v234
  v_add_f32 v210, v210, v226
  v_mfma_f32_32x32x16_bf16 a[160:175], a[100:103], v[152:155], a[160:175]
  v_add_f32 v211, v211, v219
  v_add_f32 v227, v227, v235
  v_add_f32 v211, v211, v227
  v_cvt_pk_bf16_f32 v93, v210, v211
  buffer_load_dwordx4 v[148:151], v10, s[52:55], s87 offen offset:1024 sc1
  s_add_u32 s87, s87, 45056
  s_waitcnt vmcnt(14)
  v_mfma_f32_32x32x16_bf16 a[144:159], a[104:107], v[156:159], a[144:159]
  v_add_f32 v212, v212, v220
  v_add_f32 v228, v228, v236
  v_add_f32 v212, v212, v228
  v_add_f32 v213, v213, v221
  s_load_dwordx8 s[92:99], s[26:27], s37 glc
  v_mfma_f32_32x32x16_bf16 a[160:175], a[108:111], v[156:159], a[160:175]
  v_add_f32 v229, v229, v237
  v_add_f32 v213, v213, v229
  v_cvt_pk_bf16_f32 v94, v212, v213
  buffer_load_dwordx4 v[152:155], v10, s[52:55], s87 offen offset:0 sc1
  s_waitcnt vmcnt(14)
  v_mfma_f32_32x32x16_bf16 a[176:191], a[0:3], v[160:163], 0
  v_add_f32 v214, v214, v222
  v_add_f32 v230, v230, v238
  v_add_f32 v214, v214, v230
  v_add_f32 v215, v215, v223
  v_mfma_f32_32x32x16_bf16 a[192:207], a[4:7], v[160:163], 0
  v_add_f32 v231, v231, v239
  v_add_f32 v215, v215, v231
  v_cvt_pk_bf16_f32 v96, v214, v215
  buffer_load_dwordx4 v[156:159], v10, s[52:55], s87 offen offset:1024 sc1
  s_waitcnt vmcnt(14)
  v_mfma_f32_32x32x16_bf16 a[176:191], a[8:11], v[164:167], a[176:191]
  ds_write_b128 v71, a[144:147] offset:32768
  v_mfma_f32_32x32x16_bf16 a[192:207], a[12:15], v[164:167], a[192:207]
  ds_write_b128 v80, a[148:151] offset:32768
  buffer_load_dwordx4 v[160:163], v10, s[52:55], s87 offen offset:2048 sc1
  s_waitcnt vmcnt(14)
  v_mfma_f32_32x32x16_bf16 a[176:191], a[16:19], v[168:171], a[176:191]
  v_mfma_f32_32x32x16_bf16 a[192:207], a[20:23], v[168:171], a[192:207]
  ds_write_b128 v81, a[152:155] offset:32768
  buffer_load_dwordx4 v[164:167], v10, s[52:55], s87 offen offset:3072 sc1
  s_add_u32 s87, s87, 4096
  s_waitcnt vmcnt(14)
  v_mfma_f32_32x32x16_bf16 a[176:191], a[24:27], v[172:175], a[176:191]
  ds_write_b128 v82, a[156:159] offset:32768
  v_mfma_f32_32x32x16_bf16 a[192:207], a[28:31], v[172:175], a[192:207]
  buffer_load_dwordx4 v[168:171], v10, s[52:55], s87 offen offset:0 sc1
  s_waitcnt vmcnt(14)
  v_mfma_f32_32x32x16_bf16 a[176:191], a[32:35], v[112:115], a[176:191]
  ds_write_b128 v71, a[160:163] offset:32896
  v_mfma_f32_32x32x16_bf16 a[192:207], a[36:39], v[112:115], a[192:207]
  ds_write_b128 v80, a[164:167] offset:32896
  buffer_load_dwordx4 v[172:175], v10, s[52:55], s87 offen offset:1024 sc1
  s_waitcnt vmcnt(14)
  v_mfma_f32_32x32x16_bf16 a[176:191], a[40:43], v[116:119], a[176:191]
  v_mfma_f32_32x32x16_bf16 a[192:207], a[44:47], v[116:119], a[192:207]
  s_waitcnt lgkmcnt(0)
  s_xor_b64 s[92:93], s[92:93], s[100:101]
  ds_write_b128 v81, a[168:171] offset:32896
  buffer_load_dwordx4 v[112:115], v10, s[52:55], s87 offen offset:2048 sc1
  s_waitcnt vmcnt(14)
  v_mfma_f32_32x32x16_bf16 a[176:191], a[48:51], v[120:123], a[176:191]
  s_xor_b64 s[94:95], s[94:95], s[100:101]
  ds_write_b128 v82, a[172:175] offset:32896
  v_mfma_f32_32x32x16_bf16 a[192:207], a[52:55], v[120:123], a[192:207]
  s_xor_b64 s[96:97], s[96:97], s[100:101]
  s_xor_b64 s[98:99], s[98:99], s[100:101]
  buffer_load_dwordx4 v[116:119], v10, s[52:55], s87 offen offset:3072 sc1
  s_add_u32 s87, s87, 4096
  s_waitcnt vmcnt(14)
  v_mfma_f32_32x32x16_bf16 a[176:191], a[56:59], v[124:127], a[176:191]
  s_or_b64 s[92:93], s[92:93], s[94:95]
  v_mfma_f32_32x32x16_bf16 a[192:207], a[60:63], v[124:127], a[192:207]
  s_or_b64 s[96:97], s[96:97], s[98:99]
  s_or_b64 s[92:93], s[92:93], s[96:97]
  s_cbranch_scc1 RETRY4
OK4:
  buffer_load_dwordx4 v[120:123], v10, s[52:55], s87 offen offset:0 sc1
  s_waitcnt vmcnt(14)
  v_mfma_f32_32x32x16_bf16 a[176:191], a[64:67], v[128:131], a[176:191]
  buffer_load_dwordx4 v[16:19], v90, s[52:55], s33 offen offset:0 sc1
  s_waitcnt lgkmcnt(0)
  s_barrier
  ds_read_b128 v[208:211], v83 offset:32768
  ds_read_b128 v[212:215], v84 offset:32768
  v_mfma_f32_32x32x16_bf16 a[192:207], a[68:71], v[128:131], a[192:207]
  buffer_load_dwordx4 v[20:23], v90, s[52:55], s33 offen offset:128 sc1
  ds_read_b128 v[216:219], v83 offset:40960
  ds_read_b128 v[220:223], v84 offset:40960
  buffer_load_dwordx4 v[124:127], v10, s[52:55], s87 offen offset:1024 sc1
  s_waitcnt vmcnt(16)
  v_mfma_f32_32x32x16_bf16 a[176:191], a[72:75], v[132:135], a[176:191]
  ds_read_b128 v[224:227], v83 offset:49152
  ds_read_b128 v[228:231], v84 offset:49152
  v_mfma_f32_32x32x16_bf16 a[192:207], a[76:79], v[132:135], a[192:207]
  ds_read_b128 v[232:235], v83 offset:57344
  ds_read_b128 v[236:239], v84 offset:57344
  buffer_load_dwordx4 v[128:131], v10, s[52:55], s87 offen offset:2048 sc1
  s_waitcnt vmcnt(16)
  v_mfma_f32_32x32x16_bf16 a[176:191], a[80:83], v[136:139], a[176:191]
  v_mfma_f32_32x32x16_bf16 a[192:207], a[84:87], v[136:139], a[192:207]
  buffer_load_dwordx4 v[132:135], v10, s[52:55], s87 offen offset:3072 sc1
  s_add_u32 s87, s87, 4096
  s_waitcnt vmcnt(16)
  v_mfma_f32_32x32x16_bf16 a[176:191], a[88:91], v[140:143], a[176:191]
  s_waitcnt lgkmcnt(0)
  v_add_f32 v208, v208, v216
  v_add_f32 v224, v224, v232
  v_add_f32 v208, v208, v224
  v_add_f32 v209, v209, v217
  v_add_f32 v225, v225, v233
  v_mfma_f32_32x32x16_bf16 a[192:207], a[92:95], v[140:143], a[192:207]
  v_add_f32 v209, v209, v225
  v_cvt_pk_bf16_f32 v97, v208, v209
  v_add_f32 v210, v210, v218
  v_add_f32 v226, v226, v234
  v_add_f32 v210, v210, v226
  v_add_f32 v211, v211, v219
  buffer_load_dwordx4 v[136:139], v10, s[52:55], s87 offen offset:0 sc1
  s_waitcnt vmcnt(16)
  v_mfma_f32_32x32x16_bf16 a[176:191], a[96:99], v[144:147], a[176:191]
  v_add_f32 v227, v227, v235
  v_add_f32 v211, v211, v227
  v_cvt_pk_bf16_f32 v98, v210, v211
  v_add_f32 v212, v212, v220
  v_add_f32 v228, v228, v236
  v_add_f32 v212, v212, v228
  v_mfma_f32_32x32x16_bf16 a[192:207], a[100:103], v[144:147], a[192:207]
  v_add_f32 v213, v213, v221
  v_add_f32 v229, v229, v237
  v_add_f32 v213, v213, v229
  v_cvt_pk_bf16_f32 v100, v212, v213
  v_add_f32 v214, v214, v222
  v_add_f32 v230, v230, v238
  buffer_load_dwordx4 v[140:143], v10, s[52:55], s87 offen offset:1024 sc1
  s_waitcnt vmcnt(16)
  v_mfma_f32_32x32x16_bf16 a[176:191], a[104:107], v[148:151], a[176:191]
  v_add_f32 v214, v214, v230
  v_add_f32 v215, v215, v223
  v_add_f32 v231, v231, v239
  v_add_f32 v215, v215, v231
  v_cvt_pk_bf16_f32 v101, v214, v215
  v_mfma_f32_32x32x16_bf16 a[192:207], a[108:111], v[148:151], a[192:207]
  buffer_store_dwordx4 v[92:95], v10, s[52:55], s34 offen offset:0 sc1
  s_waitcnt vmcnt(16)
  v_mfma_f32_32x32x16_bf16 a[208:223], a[0:3], v[152:155], 0
  buffer_store_dwordx4 v[96:99], v10, s[52:55], s34 offen offset:1024 sc1
  v_mfma_f32_32x32x16_bf16 a[224:239], a[4:7], v[152:155], 0
  buffer_store_dwordx4 v[100:103], v10, s[52:55], s34 offen offset:2048 sc1
  s_atomic_swap s100, s[26:27], s38
  s_waitcnt vmcnt(17)
  v_mfma_f32_32x32x16_bf16 a[208:223], a[8:11], v[156:159], a[208:223]
  ds_write_b128 v71, a[176:179] offset:0
  v_mfma_f32_32x32x16_bf16 a[224:239], a[12:15], v[156:159], a[224:239]
  ds_write_b128 v80, a[180:183] offset:0
  s_waitcnt vmcnt(16)
  v_mfma_f32_32x32x16_bf16 a[208:223], a[16:19], v[160:163], a[208:223]
  ds_write_b128 v81, a[184:187] offset:0
  v_mfma_f32_32x32x16_bf16 a[224:239], a[20:23], v[160:163], a[224:239]
  ds_write_b128 v82, a[188:191] offset:0
  s_waitcnt vmcnt(15)
  v_mfma_f32_32x32x16_bf16 a[208:223], a[24:27], v[164:167], a[208:223]
  s_waitcnt vmcnt(8)
  v_mfma_f32_32x32x16_bf16 a[224:239], a[28:31], v[164:167], a[224:239]
  ds_write2_b32 v89, v16, v20 offset0:0 offset1:32
  ds_write_b128 v71, a[192:195] offset:128
  v_mfma_f32_32x32x16_bf16 a[208:223], a[32:35], v[168:171], a[208:223]
  ds_write2_b32 v89, v17, v21 offset0:64 offset1:96
  ds_write_b128 v80, a[196:199] offset:128
  v_mfma_f32_32x32x16_bf16 a[224:239], a[36:39], v[168:171], a[224:239]
  ds_write2_b32 v89, v18, v22 offset0:128 offset1:160
  ds_write_b128 v81, a[200:203] offset:128
  v_mfma_f32_32x32x16_bf16 a[208:223], a[40:43], v[172:175], a[208:223]
  ds_write2_b32 v89, v19, v23 offset0:192 offset1:224
  ds_write_b128 v82, a[204:207] offset:128
  v_mfma_f32_32x32x16_bf16 a[224:239], a[44:47], v[172:175], a[224:239]
  v_mfma_f32_32x32x16_bf16 a[208:223], a[48:51], v[112:115], a[208:223]
  s_load_dword s72, s[26:27], s39 glc
  v_mfma_f32_32x32x16_bf16 a[224:239], a[52:55], v[112:115], a[224:239]
  ds_read_b32 v5, v40
  ds_read_b32 v5, v40
  ds_read_b32 v5, v40
  s_waitcnt lgkmcnt(3)
  s_barrier
  ds_read_b128 v[208:211], v83 offset:0
  ds_read_b128 v[212:215], v84 offset:0
  v_mfma_f32_32x32x16_bf16 a[208:223], a[56:59], v[116:119], a[208:223]
  ds_read_b128 v[216:219], v83 offset:8192
  ds_read_b128 v[220:223], v84 offset:8192
  ds_read_b128 v[200:203], v85
  ds_read_b128 v[204:207], v85 offset:4160
  v_mfma_f32_32x32x16_bf16 a[224:239], a[60:63], v[116:119], a[224:239]
  ds_read_b128 v[224:227], v83 offset:16384
  ds_read_b128 v[228:231], v84 offset:16384
  v_mfma_f32_32x32x16_bf16 a[208:223], a[64:67], v[120:123], a[208:223]
  ds_read_b128 v[232:235], v83 offset:24576
  ds_read_b128 v[236:239], v84 offset:24576
  v_mfma_f32_32x32x16_bf16 a[224:239], a[68:71], v[120:123], a[224:239]
  s_waitcnt vmcnt(7)
  v_mfma_f32_32x32x16_bf16 a[208:223], a[72:75], v[124:127], a[208:223]
  ds_read_b32 v5, v40
  ds_read_b32 v5, v40
  ds_read_b32 v5, v40
  s_waitcnt lgkmcnt(3)
  v_add_f32 v208, v208, v216
  v_add_f32 v224, v224, v232
  v_add_f32 v104, v208, v224
  v_mfma_f32_32x32x16_bf16 a[224:239], a[76:79], v[124:127], a[224:239]
  v_add_f32 v209, v209, v217
  v_add_f32 v225, v225, v233
  v_add_f32 v105, v209, v225
  s_waitcnt vmcnt(6)
  v_mfma_f32_32x32x16_bf16 a[208:223], a[80:83], v[128:131], a[208:223]
  v_add_f32 v210, v210, v218
  v_add_f32 v226, v226, v234
  v_add_f32 v106, v210, v226
  s_waitcnt vmcnt(5)
  v_mfma_f32_32x32x16_bf16 a[208:223], a[88:91], v[132:135], a[208:223]
  v_add_f32 v211, v211, v219
  v_add_f32 v227, v227, v235
  v_add_f32 v107, v211, v227
  s_waitcnt vmcnt(4)
  v_mfma_f32_32x32x16_bf16 a[208:223], a[96:99], v[136:139], a[208:223]
  v_add_f32 v212, v212, v220
  v_add_f32 v228, v228, v236
  v_add_f32 v108, v212, v228
  s_waitcnt vmcnt(3)
  v_mfma_f32_32x32x16_bf16 a[208:223], a[104:107], v[140:143], a[208:223]
  v_add_f32 v213, v213, v221
  v_add_f32 v229, v229, v237
  v_add_f32 v109, v213, v229
  v_mfma_f32_32x32x16_bf16 a[224:239], a[84:87], v[128:131], a[224:239]
  v_add_f32 v214, v214, v222
  v_add_f32 v230, v230, v238
  v_add_f32 v110, v214, v230
  v_lshlrev_b32 v176, 16, v200
  v_and_b32 v177, 0xffff0000, v200
  v_lshlrev_b32 v178, 16, v201
  v_and_b32 v179, 0xffff0000, v201
  v_mfma_f32_32x32x16_bf16 a[224:239], a[92:95], v[132:135], a[224:239]
  v_add_f32 v215, v215, v223
  v_add_f32 v231, v231, v239
  v_add_f32 v111, v215, v231
  v_lshlrev_b32 v180, 16, v202
  v_and_b32 v181, 0xffff0000, v202
  v_lshlrev_b32 v182, 16, v203
  v_and_b32 v183, 0xffff0000, v203
  s_waitcnt lgkmcnt(0)
  s_cmp_lg_u32 s72, s100
  s_cbranch_scc1 PXMISS
  buffer_load_dwordx4 v[92:95], v10, s[52:55], s35 offen offset:0 sc1
  buffer_load_dwordx4 v[96:99], v10, s[52:55], s35 offen offset:1024 sc1
  buffer_load_dwordx4 v[100:103], v10, s[52:55], s35 offen offset:2048 sc1
PXSKIP:
  v_mfma_f32_32x32x16_bf16 a[224:239], a[100:103], v[136:139], a[224:239]
  v_lshlrev_b32 v184, 16, v204
  v_and_b32 v185, 0xffff0000, v204
  v_lshlrev_b32 v186, 16, v205
  v_and_b32 v187, 0xffff0000, v205
  v_mfma_f32_32x32x16_bf16 a[224:239], a[108:111], v[140:143], a[224:239]
  v_lshlrev_b32 v188, 16, v206
  v_and_b32 v189, 0xffff0000, v206
  v_lshlrev_b32 v190, 16, v207
  v_and_b32 v191, 0xffff0000, v207
  v_pk_fma_f32 v[176:177], v[240:241], v[176:177], v[104:105]
  v_pk_fma_f32 v[178:179], v[242:243], v[178:179], v[106:107]
  v_pk_fma_f32 v[180:181], v[244:245], v[180:181], v[108:109]
  v_pk_fma_f32 v[182:183], v[246:247], v[182:183], v[110:111]
  ds_write_b128 v71, a[208:211] offset:32768
  v_pk_mul_f32 v[184:185], v[248:249], v[184:185]
  ds_write_b128 v80, a[212:215] offset:32768
  v_pk_mul_f32 v[186:187], v[250:251], v[186:187]
  ds_write_b128 v81, a[216:219] offset:32768
  v_pk_mul_f32 v[188:189], v[252:253], v[188:189]
  ds_write_b128 v82, a[220:223] offset:32768
  v_pk_mul_f32 v[190:191], v[254:255], v[190:191]
  ds_write_b128 v71, a[224:227] offset:32896
  ds_write_b128 v80, a[228:231] offset:32896
  ds_write_b128 v81, a[232:235] offset:32896
  ds_write_b128 v82, a[236:239] offset:32896
  s_cmp_lg_u32 s72, s100
  s_cbranch_scc1 PXMISS1
PXSKIP1:
  s_waitcnt lgkmcnt(0)
  s_barrier
  ds_read_b128 v[208:211], v83 offset:32768
  ds_read_b128 v[212:215], v84 offset:32768
  ds_read_b128 v[216:219], v83 offset:40960
  ds_read_b128 v[220:223], v84 offset:40960
  ds_read_b128 v[224:227], v83 offset:49152
  ds_read_b128 v[228:231], v84 offset:49152
  ds_read_b128 v[232:235], v83 offset:57344
  ds_read_b128 v[236:239], v84 offset:57344
  s_cmp_lg_u32 s72, s100
  s_cbranch_scc1 PXSLOW
PXBACK:
  s_waitcnt vmcnt(0)
  v_cmp_ne_u32 vcc, s100, v95
  v_cmp_ne_u32 s[92:93], s100, v99
  v_cmp_ne_u32 s[94:95], s100, v103
  s_or_b64 vcc, vcc, s[92:93]
  s_or_b64 vcc, vcc, s[94:95]
  s_cbranch_scc1 RETRY5
OK5:
  v_lshlrev_b32 v136, 16, v97
  v_and_b32 v137, 0xffff0000, v97
  v_lshlrev_b32 v138, 16, v98
  v_and_b32 v139, 0xffff0000, v98
  v_lshlrev_b32 v140, 16, v100
  v_and_b32 v141, 0xffff0000, v100
  v_lshlrev_b32 v142, 16, v101
  v_and_b32 v143, 0xffff0000, v101
  v_pk_add_f32 v[184:185], v[184:185], v[136:137]
  v_pk_add_f32 v[186:187], v[186:187], v[138:139]
  v_pk_add_f32 v[188:189], v[188:189], v[140:141]
  v_pk_add_f32 v[190:191], v[190:191], v[142:143]
  s_waitcnt lgkmcnt(0)
  v_pk_add_f32 v[208:209], v[208:209], v[216:217]
  v_pk_add_f32 v[224:225], v[224:225], v[232:233]
  v_pk_add_f32 v[210:211], v[210:211], v[218:219]
  v_pk_add_f32 v[226:227], v[226:227], v[234:235]
  v_pk_add_f32 v[212:213], v[212:213], v[220:221]
  v_pk_add_f32 v[228:229], v[228:229], v[236:237]
  v_pk_add_f32 v[214:215], v[214:215], v[222:223]
  v_pk_add_f32 v[230:231], v[230:231], v[238:239]
  v_pk_add_f32 v[184:185], v[184:185], v[208:209]
  v_pk_add_f32 v[186:187], v[186:187], v[210:211]
  v_pk_add_f32 v[188:189], v[188:189], v[212:213]
  v_pk_add_f32 v[190:191], v[190:191], v[214:215]
  v_pk_add_f32 v[184:185], v[184:185], v[224:225]
  v_pk_add_f32 v[186:187], v[186:187], v[226:227]
  v_pk_add_f32 v[188:189], v[188:189], v[228:229]
  v_pk_add_f32 v[190:191], v[190:191], v[230:231]
  v_pk_fma_f32 v[184:185], v[184:185], v[78:79], v[32:33] op_sel:[0,1,0] op_sel_hi:[1,1,1]
  v_pk_fma_f32 v[186:187], v[186:187], v[78:79], v[34:35] op_sel:[0,1,0] op_sel_hi:[1,1,1]
  v_pk_fma_f32 v[188:189], v[188:189], v[78:79], v[36:37] op_sel:[0,1,0] op_sel_hi:[1,1,1]
  v_pk_fma_f32 v[190:191], v[190:191], v[78:79], v[38:39] op_sel:[0,1,0] op_sel_hi:[1,1,1]
  v_cvt_pk_bf16_f32 v196, v184, v185
  v_cvt_pk_bf16_f32 v197, v186, v187
  v_cvt_pk_bf16_f32 v198, v188, v189
  v_cvt_pk_bf16_f32 v199, v190, v191
  buffer_store_dwordx4 v[196:199], v62, s[56:59], s73 offen sc1
  v_lshlrev_b32 v128, 16, v92
  v_and_b32 v129, 0xffff0000, v92
  v_lshlrev_b32 v130, 16, v93
  v_and_b32 v131, 0xffff0000, v93
  v_lshlrev_b32 v132, 16, v94
  v_and_b32 v133, 0xffff0000, v94
  v_lshlrev_b32 v134, 16, v96
  v_and_b32 v135, 0xffff0000, v96
  v_pk_add_f32 v[176:177], v[176:177], v[128:129]
  v_pk_add_f32 v[178:179], v[178:179], v[130:131]
  v_pk_add_f32 v[180:181], v[180:181], v[132:133]
  v_pk_add_f32 v[182:183], v[182:183], v[134:135]
  v_pk_fma_f32 v[176:177], v[176:177], v[76:77], v[24:25] op_sel:[0,1,0] op_sel_hi:[1,1,1]
  v_pk_fma_f32 v[178:179], v[178:179], v[76:77], v[26:27] op_sel:[0,1,0] op_sel_hi:[1,1,1]
  v_pk_fma_f32 v[180:181], v[180:181], v[76:77], v[28:29] op_sel:[0,1,0] op_sel_hi:[1,1,1]
  v_pk_fma_f32 v[182:183], v[182:183], v[76:77], v[30:31] op_sel:[0,1,0] op_sel_hi:[1,1,1]
  v_cvt_pk_bf16_f32 v192, v176, v177
  v_cvt_pk_bf16_f32 v193, v178, v179
  v_cvt_pk_bf16_f32 v194, v180, v181
  v_cvt_pk_bf16_f32 v195, v182, v183
  buffer_store_dwordx4 v[192:195], v62, s[56:59], s90 offen sc1
END:
  s_endpgm
RETRY0:
  s_mov_b32 s3, 2000000
RL0:
  buffer_load_dwordx4 v[152:155], v60, s[52:55], s91 offen offset:0 sc1
  buffer_load_dwordx4 v[156:159], v60, s[52:55], s91 offen offset:128 sc1
  buffer_load_dwordx4 v[160:163], v60, s[52:55], s91 offen offset:256 sc1
  s_sub_u32 s3, s3, 1
  s_cmp_eq_u32 s3, 0
  s_waitcnt vmcnt(0)
  s_cbranch_scc1 OK0
  v_cmp_ne_u32 vcc, s100, v155
  v_cmp_ne_u32 s[92:93], s100, v159
  v_cmp_ne_u32 s[94:95], s100, v163
  s_or_b64 vcc, vcc, s[92:93]
  s_or_b64 vcc, vcc, s[94:95]
  s_cbranch_scc1 RL0
  s_branch OK0
DOX0:
  ds_read_b128 v[104:107], v68 offset:0
  ds_read_b128 v[108:111], v68 offset:4096
  s_branch NOX0
DOX1:
  ds_read_b128 v[104:107], v68 offset:32768
  ds_read_b128 v[108:111], v68 offset:36864
  s_branch NOX1
DOX2:
  v_add_u32 v70, 0x10000, v68
  ds_read_b128 v[104:107], v70 offset:0
  ds_read_b128 v[108:111], v70 offset:4096
  s_branch NOX2
DOX3:
  ds_read_b128 v[104:107], v68 offset:0
  ds_read_b128 v[108:111], v68 offset:4096
  s_branch NOX3
DOX4:
  ds_read_b128 v[104:107], v68 offset:32768
  ds_read_b128 v[108:111], v68 offset:36864
  s_branch NOX4
RETRY1:
  s_mov_b32 s3, 2000000
RL1:
  s_load_dwordx8 s[92:99], s[26:27], s82 glc
  s_sub_u32 s3, s3, 1
  s_cmp_eq_u32 s3, 0
  s_waitcnt lgkmcnt(0)
  s_cbranch_scc1 OK1
  s_xor_b64 s[92:93], s[92:93], s[100:101]
  s_xor_b64 s[94:95], s[94:95], s[100:101]
  s_xor_b64 s[96:97], s[96:97], s[100:101]
  s_xor_b64 s[98:99], s[98:99], s[100:101]
  s_or_b64 s[92:93], s[92:93], s[94:95]
  s_or_b64 s[96:97], s[96:97], s[98:99]
  s_or_b64 s[92:93], s[92:93], s[96:97]
  s_cbranch_scc1 RL1
  s_branch OK1
DOX5:
  v_add_u32 v70, 0x10000, v68
  ds_read_b128 v[104:107], v70 offset:0
  ds_read_b128 v[108:111], v70 offset:4096
  s_branch NOX5
DOX6:
  ds_read_b128 v[104:107], v68 offset:0
  ds_read_b128 v[108:111], v68 offset:4096
  s_branch NOX6
RETRY2:
  s_mov_b32 s3, 2000000
RL2:
  buffer_load_dwordx4 v[136:139], v10, s[52:55], s78 offen sc1
  buffer_load_dwordx4 v[140:143], v10, s[52:55], s79 offen sc1
  s_sub_u32 s3, s3, 1
  s_cmp_eq_u32 s3, 0
  s_waitcnt vmcnt(0)
  s_cbranch_scc1 OK2
  v_cmp_ne_u32 vcc, s100, v139
  v_cmp_ne_u32 s[92:93], s100, v142
  s_nop 0
  s_or_b64 vcc, vcc, s[92:93]
  s_cbranch_scc1 RL2
  s_branch OK2
RETRY3:
  s_mov_b32 s3, 2000000
RL3:
  s_load_dwordx8 s[92:99], s[26:27], s85 glc
  s_sub_u32 s3, s3, 1
  s_cmp_eq_u32 s3, 0
  s_waitcnt lgkmcnt(0)
  s_cbranch_scc1 OK3
  s_xor_b64 s[92:93], s[92:93], s[100:101]
  s_xor_b64 s[94:95], s[94:95], s[100:101]
  s_xor_b64 s[96:97], s[96:97], s[100:101]
  s_xor_b64 s[98:99], s[98:99], s[100:101]
  s_or_b64 s[92:93], s[92:93], s[94:95]
  s_or_b64 s[96:97], s[96:97], s[98:99]
  s_or_b64 s[92:93], s[92:93], s[96:97]
  s_cbranch_scc1 RL3
  s_branch OK3
RETRY4:
  s_mov_b32 s3, 2000000
RL4:
  s_load_dwordx8 s[92:99], s[26:27], s37 glc
  s_sub_u32 s3, s3, 1
  s_cmp_eq_u32 s3, 0
  s_waitcnt lgkmcnt(0)
  s_cbranch_scc1 OK4
  s_xor_b64 s[92:93], s[92:93], s[100:101]
  s_xor_b64 s[94:95], s[94:95], s[100:101]
  s_xor_b64 s[96:97], s[96:97], s[100:101]
  s_xor_b64 s[98:99], s[98:99], s[100:101]
  s_or_b64 s[92:93], s[92:93], s[94:95]
  s_or_b64 s[96:97], s[96:97], s[98:99]
  s_or_b64 s[92:93], s[92:93], s[96:97]
  s_cbranch_scc1 RL4
  s_branch OK4
PXMISS:
  s_load_dword s92, s[26:27], s39 glc
  s_branch PXSKIP
PXMISS1:
  s_waitcnt lgkmcnt(0)
  s_mov_b32 s72, s92
  s_cmp_lg_u32 s72, s100
  s_cbranch_scc1 PXSKIP1
  buffer_load_dwordx4 v[92:95], v10, s[52:55], s35 offen offset:0 sc1
  buffer_load_dwordx4 v[96:99], v10, s[52:55], s35 offen offset:1024 sc1
  buffer_load_dwordx4 v[100:103], v10, s[52:55], s35 offen offset:2048 sc1
  s_branch PXSKIP1
PXSLOW:
  s_mov_b32 s3, 2000000
PXL:
  s_load_dword s72, s[26:27], s39 glc
  s_sub_u32 s3, s3, 1
  s_cmp_eq_u32 s3, 0
  s_waitcnt lgkmcnt(0)
  s_cbranch_scc1 PXGO
  s_cmp_lg_u32 s72, s100
  s_cbranch_scc1 PXL
PXGO:
  buffer_load_dwordx4 v[92:95], v10, s[52:55], s35 offen offset:0 sc1
  buffer_load_dwordx4 v[96:99], v10, s[52:55], s35 offen offset:1024 sc1
  buffer_load_dwordx4 v[100:103], v10, s[52:55], s35 offen offset:2048 sc1
  s_branch PXBACK
RETRY5:
  s_mov_b32 s3, 2000000
RL5:
  buffer_load_dwordx4 v[92:95], v10, s[52:55], s35 offen offset:0 sc1
  buffer_load_dwordx4 v[96:99], v10, s[52:55], s35 offen offset:1024 sc1
  buffer_load_dwordx4 v[100:103], v10, s[52:55], s35 offen offset:2048 sc1
  s_sub_u32 s3, s3, 1
  s_cmp_eq_u32 s3, 0
  s_waitcnt vmcnt(0)
  s_cbranch_scc1 OK5
  v_cmp_ne_u32 vcc, s100, v95
  v_cmp_ne_u32 s[92:93], s100, v99
  v_cmp_ne_u32 s[94:95], s100, v103
  s_or_b64 vcc, vcc, s[92:93]
  s_or_b64 vcc, vcc, s[94:95]
  s_cbranch_scc1 RL5
  s_branch OK5
HCONT:
  s_waitcnt vmcnt(12)
  v_dot2_f32_bf16 v16, v32, v14, v16
  v_dot2_f32_bf16 v17, v32, v32, v17
  v_dot2_f32_bf16 v18, v36, v14, v18
  v_dot2_f32_bf16 v19, v36, v36, v19
  v_dot2_f32_bf16 v16, v33, v14, v16
  v_dot2_f32_bf16 v17, v33, v33, v17
  v_dot2_f32_bf16 v18, v37, v14, v18
  v_dot2_f32_bf16 v19, v37, v37, v19
  v_dot2_f32_bf16 v16, v34, v14, v16
  v_dot2_f32_bf16 v17, v34, v34, v17
  v_dot2_f32_bf16 v18, v38, v14, v18
  v_dot2_f32_bf16 v19, v38, v38, v19
  v_dot2_f32_bf16 v16, v35, v14, v16
  v_dot2_f32_bf16 v17, v35, v35, v17
  v_dot2_f32_bf16 v18, v39, v14, v18
  v_dot2_f32_bf16 v19, v39, v39, v19
  v_lshlrev_b32 v160, 16, v40
  v_and_b32 v161, 0xffff0000, v40
  v_lshlrev_b32 v162, 16, v41
  v_and_b32 v163, 0xffff0000, v41
  v_lshlrev_b32 v164, 16, v42
  v_and_b32 v165, 0xffff0000, v42
  v_lshlrev_b32 v166, 16, v43
  v_and_b32 v167, 0xffff0000, v43
  v_pk_add_f32 v[150:151], v[150:151], v[160:161]
  v_pk_add_f32 v[152:153], v[152:153], v[162:163]
  v_pk_add_f32 v[154:155], v[154:155], v[164:165]
  v_pk_add_f32 v[156:157], v[156:157], v[166:167]
  v_lshlrev_b32 v160, 16, v44
  v_and_b32 v161, 0xffff0000, v44
  v_lshlrev_b32 v162, 16, v45
  v_and_b32 v163, 0xffff0000, v45
  v_lshlrev_b32 v164, 16, v46
  v_and_b32 v165, 0xffff0000, v46
  v_lshlrev_b32 v166, 16, v47
  v_and_b32 v167, 0xffff0000, v47
  v_pk_add_f32 v[150:151], v[150:151], v[160:161]
  v_pk_add_f32 v[152:153], v[152:153], v[162:163]
  v_pk_add_f32 v[154:155], v[154:155], v[164:165]
  v_pk_add_f32 v[156:157], v[156:157], v[166:167]
  s_add_u32 s73, s68, 917504
  buffer_load_dwordx4 v[96:99], v7, s[28:31], s67 offen offset:512
  buffer_load_dwordx4 v[104:107], v9, s[40:43], s73 offen
  buffer_load_dwordx4 v[100:103], v8, s[28:31], s67 offen offset:512
  buffer_load_dwordx4 v[108:111], v24, s[40:43], s73 offen
  s_waitcnt vmcnt(12)
  v_dot2_f32_bf16 v16, v48, v14, v16
  v_dot2_f32_bf16 v17, v48, v48, v17
  v_dot2_f32_bf16 v18, v52, v14, v18
  v_dot2_f32_bf16 v19, v52, v52, v19
  v_dot2_f32_bf16 v16, v49, v14, v16
  v_dot2_f32_bf16 v17, v49, v49, v17
  v_dot2_f32_bf16 v18, v53, v14, v18
  v_dot2_f32_bf16 v19, v53, v53, v19
  v_dot2_f32_bf16 v16, v50, v14, v16
  v_dot2_f32_bf16 v17, v50, v50, v17
  v_dot2_f32_bf16 v18, v54, v14, v18
  v_dot2_f32_bf16 v19, v54, v54, v19
  v_dot2_f32_bf16 v16, v51, v14, v16
  v_dot2_f32_bf16 v17, v51, v51, v17
  v_dot2_f32_bf16 v18, v55, v14, v18
  v_dot2_f32_bf16 v19, v55, v55, v19
  v_lshlrev_b32 v160, 16, v56
  v_and_b32 v161, 0xffff0000, v56
  v_lshlrev_b32 v162, 16, v57
  v_and_b32 v163, 0xffff0000, v57
  v_lshlrev_b32 v164, 16, v58
  v_and_b32 v165, 0xffff0000, v58
  v_lshlrev_b32 v166, 16, v59
  v_and_b32 v167, 0xffff0000, v59
  v_pk_add_f32 v[150:151], v[150:151], v[160:161]
  v_pk_add_f32 v[152:153], v[152:153], v[162:163]
  v_pk_add_f32 v[154:155], v[154:155], v[164:165]
  v_pk_add_f32 v[156:157], v[156:157], v[166:167]
  v_lshlrev_b32 v160, 16, v60
  v_and_b32 v161, 0xffff0000, v60
  v_lshlrev_b32 v162, 16, v61
  v_and_b32 v163, 0xffff0000, v61
  v_lshlrev_b32 v164, 16, v62
  v_and_b32 v165, 0xffff0000, v62
  v_lshlrev_b32 v166, 16, v63
  v_and_b32 v167, 0xffff0000, v63
  v_pk_add_f32 v[150:151], v[150:151], v[160:161]
  v_pk_add_f32 v[152:153], v[152:153], v[162:163]
  v_pk_add_f32 v[154:155], v[154:155], v[164:165]
  v_pk_add_f32 v[156:157], v[156:157], v[166:167]
  s_add_u32 s73, s68, 1146880
  buffer_load_dwordx4 v[112:115], v7, s[28:31], s67 offen offset:640
  buffer_load_dwordx4 v[120:123], v9, s[40:43], s73 offen
  buffer_load_dwordx4 v[116:119], v8, s[28:31], s67 offen offset:640
  buffer_load_dwordx4 v[124:127], v24, s[40:43], s73 offen
  s_waitcnt vmcnt(12)
  v_dot2_f32_bf16 v16, v64, v14, v16
  v_dot2_f32_bf16 v17, v64, v64, v17
  v_dot2_f32_bf16 v18, v68, v14, v18
  v_dot2_f32_bf16 v19, v68, v68, v19
  v_dot2_f32_bf16 v16, v65, v14, v16
  v_dot2_f32_bf16 v17, v65, v65, v17
  v_dot2_f32_bf16 v18, v69, v14, v18
  v_dot2_f32_bf16 v19, v69, v69, v19
  v_dot2_f32_bf16 v16, v66, v14, v16
  v_dot2_f32_bf16 v17, v66, v66, v17
  v_dot2_f32_bf16 v18, v70, v14, v18
  v_dot2_f32_bf16 v19, v70, v70, v19
  v_dot2_f32_bf16 v16, v67, v14, v16
  v_dot2_f32_bf16 v17, v67, v67, v17
  v_dot2_f32_bf16 v18, v71, v14, v18
  v_dot2_f32_bf16 v19, v71, v71, v19
  v_lshlrev_b32 v160, 16, v72
  v_and_b32 v161, 0xffff0000, v72
  v_lshlrev_b32 v162, 16, v73
  v_and_b32 v163, 0xffff0000, v73
  v_lshlrev_b32 v164, 16, v74
  v_and_b32 v165, 0xffff0000, v74
  v_lshlrev_b32 v166, 16, v75
  v_and_b32 v167, 0xffff0000, v75
  v_pk_add_f32 v[150:151], v[150:151], v[160:161]
  v_pk_add_f32 v[152:153], v[152:153], v[162:163]
  v_pk_add_f32 v[154:155], v[154:155], v[164:165]
  v_pk_add_f32 v[156:157], v[156:157], v[166:167]
  v_lshlrev_b32 v160, 16, v76
  v_and_b32 v161, 0xffff0000, v76
  v_lshlrev_b32 v162, 16, v77
  v_and_b32 v163, 0xffff0000, v77
  v_lshlrev_b32 v164, 16, v78
  v_and_b32 v165, 0xffff0000, v78
  v_lshlrev_b32 v166, 16, v79
  v_and_b32 v167, 0xffff0000, v79
  v_pk_add_f32 v[150:151], v[150:151], v[160:161]
  v_pk_add_f32 v[152:153], v[152:153], v[162:163]
  v_pk_add_f32 v[154:155], v[154:155], v[164:165]
  v_pk_add_f32 v[156:157], v[156:157], v[166:167]
  s_add_u32 s73, s68, 1376256
  buffer_load_dwordx4 v[128:131], v7, s[28:31], s67 offen offset:768
  buffer_load_dwordx4 v[136:139], v9, s[40:43], s73 offen
  buffer_load_dwordx4 v[132:135], v8, s[28:31], s67 offen offset:768
  buffer_load_dwordx4 v[140:143], v24, s[40:43], s73 offen
  s_waitcnt vmcnt(12)
  v_dot2_f32_bf16 v16, v80, v14, v16
  v_dot2_f32_bf16 v17, v80, v80, v17
  v_dot2_f32_bf16 v18, v84, v14, v18
  v_dot2_f32_bf16 v19, v84, v84, v19
  v_dot2_f32_bf16 v16, v81, v14, v16
  v_dot2_f32_bf16 v17, v81, v81, v17
  v_dot2_f32_bf16 v18, v85, v14, v18
  v_dot2_f32_bf16 v19, v85, v85, v19
  v_dot2_f32_bf16 v16, v82, v14, v16
  v_dot2_f32_bf16 v17, v82, v82, v17
  v_dot2_f32_bf16 v18, v86, v14, v18
  v_dot2_f32_bf16 v19, v86, v86, v19
  v_dot2_f32_bf16 v16, v83, v14, v16
  v_dot2_f32_bf16 v17, v83, v83, v17
  v_dot2_f32_bf16 v18, v87, v14, v18
  v_dot2_f32_bf16 v19, v87, v87, v19
  v_lshlrev_b32 v160, 16, v88
  v_and_b32 v161, 0xffff0000, v88
  v_lshlrev_b32 v162, 16, v89
  v_and_b32 v163, 0xffff0000, v89
  v_lshlrev_b32 v164, 16, v90
  v_and_b32 v165, 0xffff0000, v90
  v_lshlrev_b32 v166, 16, v91
  v_and_b32 v167, 0xffff0000, v91
  v_pk_add_f32 v[150:151], v[150:151], v[160:161]
  v_pk_add_f32 v[152:153], v[152:153], v[162:163]
  v_pk_add_f32 v[154:155], v[154:155], v[164:165]
  v_pk_add_f32 v[156:157], v[156:157], v[166:167]
  v_lshlrev_b32 v160, 16, v92
  v_and_b32 v161, 0xffff0000, v92
  v_lshlrev_b32 v162, 16, v93
  v_and_b32 v163, 0xffff0000, v93
  v_lshlrev_b32 v164, 16, v94
  v_and_b32 v165, 0xffff0000, v94
  v_lshlrev_b32 v166, 16, v95
  v_and_b32 v167, 0xffff0000, v95
  v_pk_add_f32 v[150:151], v[150:151], v[160:161]
  v_pk_add_f32 v[152:153], v[152:153], v[162:163]
  v_pk_add_f32 v[154:155], v[154:155], v[164:165]
  v_pk_add_f32 v[156:157], v[156:157], v[166:167]
  s_waitcnt vmcnt(8)
  v_dot2_f32_bf16 v16, v96, v14, v16
  v_dot2_f32_bf16 v17, v96, v96, v17
  v_dot2_f32_bf16 v18, v100, v14, v18
  v_dot2_f32_bf16 v19, v100, v100, v19
  v_dot2_f32_bf16 v16, v97, v14, v16
  v_dot2_f32_bf16 v17, v97, v97, v17
  v_dot2_f32_bf16 v18, v101, v14, v18
  v_dot2_f32_bf16 v19, v101, v101, v19
  v_dot2_f32_bf16 v16, v98, v14, v16
  v_dot2_f32_bf16 v17, v98, v98, v17
  v_dot2_f32_bf16 v18, v102, v14, v18
  v_dot2_f32_bf16 v19, v102, v102, v19
  v_dot2_f32_bf16 v16, v99, v14, v16
  v_dot2_f32_bf16 v17, v99, v99, v17
  v_dot2_f32_bf16 v18, v103, v14, v18
  v_dot2_f32_bf16 v19, v103, v103, v19
  v_lshlrev_b32 v160, 16, v104
  v_and_b32 v161, 0xffff0000, v104
  v_lshlrev_b32 v162, 16, v105
  v_and_b32 v163, 0xffff0000, v105
  v_lshlrev_b32 v164, 16, v106
  v_and_b32 v165, 0xffff0000, v106
  v_lshlrev_b32 v166, 16, v107
  v_and_b32 v167, 0xffff0000, v107
  v_pk_add_f32 v[150:151], v[150:151], v[160:161]
  v_pk_add_f32 v[152:153], v[152:153], v[162:163]
  v_pk_add_f32 v[154:155], v[154:155], v[164:165]
  v_pk_add_f32 v[156:157], v[156:157], v[166:167]
  v_lshlrev_b32 v160, 16, v108
  v_and_b32 v161, 0xffff0000, v108
  v_lshlrev_b32 v162, 16, v109
  v_and_b32 v163, 0xffff0000, v109
  v_lshlrev_b32 v164, 16, v110
  v_and_b32 v165, 0xffff0000, v110
  v_lshlrev_b32 v166, 16, v111
  v_and_b32 v167, 0xffff0000, v111
  v_pk_add_f32 v[150:151], v[150:151], v[160:161]
  v_pk_add_f32 v[152:153], v[152:153], v[162:163]
  v_pk_add_f32 v[154:155], v[154:155], v[164:165]
  v_pk_add_f32 v[156:157], v[156:157], v[166:167]
  s_waitcnt vmcnt(4)
  v_dot2_f32_bf16 v16, v112, v14, v16
  v_dot2_f32_bf16 v17, v112, v112, v17
  v_dot2_f32_bf16 v18, v116, v14, v18
  v_dot2_f32_bf16 v19, v116, v116, v19
  v_dot2_f32_bf16 v16, v113, v14, v16
  v_dot2_f32_bf16 v17, v113, v113, v17
  v_dot2_f32_bf16 v18, v117, v14, v18
  v_dot2_f32_bf16 v19, v117, v117, v19
  v_dot2_f32_bf16 v16, v114, v14, v16
  v_dot2_f32_bf16 v17, v114, v114, v17
  v_dot2_f32_bf16 v18, v118, v14, v18
  v_dot2_f32_bf16 v19, v118, v118, v19
  v_dot2_f32_bf16 v16, v115, v14, v16
  v_dot2_f32_bf16 v17, v115, v115, v17
  v_dot2_f32_bf16 v18, v119, v14, v18
  v_dot2_f32_bf16 v19, v119, v119, v19
  v_lshlrev_b32 v160, 16, v120
  v_and_b32 v161, 0xffff0000, v120
  v_lshlrev_b32 v162, 16, v121
  v_and_b32 v163, 0xffff0000, v121
  v_lshlrev_b32 v164, 16, v122
  v_and_b32 v165, 0xffff0000, v122
  v_lshlrev_b32 v166, 16, v123
  v_and_b32 v167, 0xffff0000, v123
  v_pk_add_f32 v[150:151], v[150:151], v[160:161]
  v_pk_add_f32 v[152:153], v[152:153], v[162:163]
  v_pk_add_f32 v[154:155], v[154:155], v[164:165]
  v_pk_add_f32 v[156:157], v[156:157], v[166:167]
  v_lshlrev_b32 v160, 16, v124
  v_and_b32 v161, 0xffff0000, v124
  v_lshlrev_b32 v162, 16, v125
  v_and_b32 v163, 0xffff0000, v125
  v_lshlrev_b32 v164, 16, v126
  v_and_b32 v165, 0xffff0000, v126
  v_lshlrev_b32 v166, 16, v127
  v_and_b32 v167, 0xffff0000, v127
  v_pk_add_f32 v[150:151], v[150:151], v[160:161]
  v_pk_add_f32 v[152:153], v[152:153], v[162:163]
  v_pk_add_f32 v[154:155], v[154:155], v[164:165]
  v_pk_add_f32 v[156:157], v[156:157], v[166:167]
  s_waitcnt vmcnt(0)
  v_dot2_f32_bf16 v16, v128, v14, v16
  v_dot2_f32_bf16 v17, v128, v128, v17
  v_dot2_f32_bf16 v18, v132, v14, v18
  v_dot2_f32_bf16 v19, v132, v132, v19
  v_dot2_f32_bf16 v16, v129, v14, v16
  v_dot2_f32_bf16 v17, v129, v129, v17
  v_dot2_f32_bf16 v18, v133, v14, v18
  v_dot2_f32_bf16 v19, v133, v133, v19
  v_dot2_f32_bf16 v16, v130, v14, v16
  v_dot2_f32_bf16 v17, v130, v130, v17
  v_dot2_f32_bf16 v18, v134, v14, v18
  v_dot2_f32_bf16 v19, v134, v134, v19
  v_dot2_f32_bf16 v16, v131, v14, v16
  v_dot2_f32_bf16 v17, v131, v131, v17
  v_dot2_f32_bf16 v18, v135, v14, v18
  v_dot2_f32_bf16 v19, v135, v135, v19
  v_lshlrev_b32 v160, 16, v136
  v_and_b32 v161, 0xffff0000, v136
  v_lshlrev_b32 v162, 16, v137
  v_and_b32 v163, 0xffff0000, v137
  v_lshlrev_b32 v164, 16, v138
  v_and_b32 v165, 0xffff0000, v138
  v_lshlrev_b32 v166, 16, v139
  v_and_b32 v167, 0xffff0000, v139
  v_pk_add_f32 v[150:151], v[150:151], v[160:161]
  v_pk_add_f32 v[152:153], v[152:153], v[162:163]
  v_pk_add_f32 v[154:155], v[154:155], v[164:165]
  v_pk_add_f32 v[156:157], v[156:157], v[166:167]
  v_lshlrev_b32 v160, 16, v140
  v_and_b32 v161, 0xffff0000, v140
  v_lshlrev_b32 v162, 16, v141
  v_and_b32 v163, 0xffff0000, v141
  v_lshlrev_b32 v164, 16, v142
  v_and_b32 v165, 0xffff0000, v142
  v_lshlrev_b32 v166, 16, v143
  v_and_b32 v167, 0xffff0000, v143
  v_pk_add_f32 v[150:151], v[150:151], v[160:161]
  v_pk_add_f32 v[152:153], v[152:153], v[162:163]
  v_pk_add_f32 v[154:155], v[154:155], v[164:165]
  v_pk_add_f32 v[156:157], v[156:157], v[166:167]
  v_lshlrev_b32 v25, 5, v0
  ds_write_b64 v25, v[152:153] offset:8
  ds_write_b64 v25, v[154:155] offset:16
  ds_write_b64 v25, v[150:151]
  ds_write_b64 v25, v[156:157] offset:24
  v_add_f32_dpp v16, v16, v16 quad_perm:[1,0,3,2] row_mask:0xf bank_mask:0xf
  v_add_f32_dpp v17, v17, v17 quad_perm:[1,0,3,2] row_mask:0xf bank_mask:0xf
  v_add_f32_dpp v18, v18, v18 quad_perm:[1,0,3,2] row_mask:0xf bank_mask:0xf
  v_add_f32_dpp v19, v19, v19 quad_perm:[1,0,3,2] row_mask:0xf bank_mask:0xf
  v_add_f32_dpp v16, v16, v16 quad_perm:[2,3,0,1] row_mask:0xf bank_mask:0xf
  v_add_f32_dpp v17, v17, v17 quad_perm:[2,3,0,1] row_mask:0xf bank_mask:0xf
  v_add_f32_dpp v18, v18, v18 quad_perm:[2,3,0,1] row_mask:0xf bank_mask:0xf
  v_add_f32_dpp v19, v19, v19 quad_perm:[2,3,0,1] row_mask:0xf bank_mask:0xf
  v_add_f32_dpp v16, v16, v16 row_half_mirror row_mask:0xf bank_mask:0xf
  v_add_f32_dpp v17, v17, v17 row_half_mirror row_mask:0xf bank_mask:0xf
  v_add_f32_dpp v18, v18, v18 row_half_mirror row_mask:0xf bank_mask:0xf
  v_add_f32_dpp v19, v19, v19 row_half_mirror row_mask:0xf bank_mask:0xf
  v_cmp_eq_u32 vcc, 1, v6
  s_waitcnt lgkmcnt(0)
  s_barrier
  v_lshlrev_b32 v26, 2, v4
  ds_read2st64_b32 v[32:33], v26 offset0:0 offset1:1
  ds_read2st64_b32 v[34:35], v26 offset0:2 offset1:3
  ds_read2st64_b32 v[36:37], v26 offset0:4 offset1:5
  ds_read2st64_b32 v[38:39], v26 offset0:6 offset1:7
  ds_read2st64_b32 v[40:41], v26 offset0:8 offset1:9
  ds_read2st64_b32 v[42:43], v26 offset0:10 offset1:11
  ds_read2st64_b32 v[44:45], v26 offset0:12 offset1:13
  ds_read2st64_b32 v[46:47], v26 offset0:14 offset1:15
  ds_read2st64_b32 v[48:49], v26 offset0:16 offset1:17
  ds_read2st64_b32 v[50:51], v26 offset0:18 offset1:19
  ds_read2st64_b32 v[52:53], v26 offset0:20 offset1:21
  ds_read2st64_b32 v[54:55], v26 offset0:22 offset1:23
  ds_read2st64_b32 v[56:57], v26 offset0:24 offset1:25
  ds_read2st64_b32 v[58:59], v26 offset0:26 offset1:27
  ds_read2st64_b32 v[60:61], v26 offset0:28 offset1:29
  ds_read2st64_b32 v[62:63], v26 offset0:30 offset1:31
  s_mul_i32 s101, s100, 2654435761
  s_add_u32 s101, s101, 2135587861
  s_and_b32 s100, s101, 3221209087
  v_cndmask_b32 v16, v16, v18, vcc
  v_cndmask_b32 v17, v17, v19, vcc
  v_mul_f32 v16, -0.002232142857142857, v16
  v_mul_f32 v17, 0.002232142857142857, v17
  v_fma_f32 v17, -v16, v16, v17
  v_max_f32 v17, 0, v17
  v_cvt_pk_bf16_f32 v17, v17, v17
  v_lshlrev_b32 v17, 16, v17
  v_add_f32 v17, 0x3727c5ac, v17
  v_cvt_pk_bf16_f32 v17, v17, v17
  v_lshlrev_b32 v17, 16, v17
  v_sqrt_f32 v17, v17
  v_lshl_add_u32 v20, v6, 3, v5
  v_lshlrev_b32 v20, 4, v20
  v_cvt_pk_bf16_f32 v17, v16, v17
  v_cvt_pk_bf16_f32 v16, v16, v16
  v_mov_b32 v18, 0
  v_mov_b32 v19, s100
  s_lshl_b32 s67, s66, 2
  s_add_u32 s67, s67, s60
  s_lshl_b32 s67, s67, 8
  s_add_u32 s67, s67, 360448
  v_cmp_gt_u32 vcc, 2, v6
  s_nop 0
  s_and_saveexec_b64 s[70:71], vcc
  buffer_store_dwordx4 v[16:19], v20, s[52:55], s67 offen sc1
  s_mov_b64 exec, s[70:71]
  s_cmp_lg_u32 s60, 0
  s_cbranch_scc1 HPOST
  s_waitcnt lgkmcnt(0)
  v_pk_add_f32 v[32:33], v[32:33], v[48:49]
  v_pk_add_f32 v[34:35], v[34:35], v[50:51]
  v_pk_add_f32 v[36:37], v[36:37], v[52:53]
  v_pk_add_f32 v[38:39], v[38:39], v[54:55]
  v_pk_add_f32 v[40:41], v[40:41], v[56:57]
  v_pk_add_f32 v[42:43], v[42:43], v[58:59]
  v_pk_add_f32 v[44:45], v[44:45], v[60:61]
  v_pk_add_f32 v[46:47], v[46:47], v[62:63]
  v_pk_add_f32 v[32:33], v[32:33], v[40:41]
  v_pk_add_f32 v[34:35], v[34:35], v[42:43]
  v_pk_add_f32 v[36:37], v[36:37], v[44:45]
  v_pk_add_f32 v[38:39], v[38:39], v[46:47]
  v_pk_add_f32 v[32:33], v[32:33], v[36:37]
  v_pk_add_f32 v[34:35], v[34:35], v[38:39]
  v_pk_add_f32 v[32:33], v[32:33], v[34:35]
  v_add_f32 v32, v32, v33
  v_and_b32 v33, 0xffff0000, v32
  v_sub_f32 v34, v32, v33
  v_and_b32 v35, 0xffff0000, v34
  v_sub_f32 v34, v34, v35
  v_lshrrev_b32 v33, 16, v33
  v_or_b32 v36, v33, v35
  v_lshrrev_b32 v37, 16, v34
  v_mov_b32 v38, s100
  v_mov_b32 v39, 0
  v_lshlrev_b32 v26, 4, v4
  s_lshl_b32 s72, s72, 10
  s_add_u32 s72, s72, 393216
  buffer_store_dwordx4 v[36:39], v26, s[52:55], s72 offen sc1
HPOST:
  s_lshl_b32 s69, s64, 2
  s_add_u32 s69, s69, s62
  s_lshl_b32 s69, s69, 2
  s_add_u32 s69, s69, s63
  s_mul_i32 s69, s69, 50176
  v_lshlrev_b32 v11, 7, v0
  v_add_u32 v12, 32768, v11
  v_min_u32 v12, 50048, v12
  buffer_load_dword v10, v11, s[44:47], s69 offen
  buffer_load_dword v10, v12, s[44:47], s69 offen
  s_cmp_lg_u32 s2, 0
  s_cbranch_scc1 HEND
  v_lshrrev_b32 v21, 3, v0
  v_lshlrev_b32 v21, 9, v21
  v_lshl_add_u32 v21, v6, 2, v21
  v_add_u32 v21, 4096, v21
  v_subrev_u32 v22, 224, v0
  v_lshlrev_b32 v22, 10, v22
  v_add_u32 v22, 360460, v22
  v_cmp_gt_u32 vcc, 224, v0
  s_mov_b32 s3, 2000000
  s_nop 0
  v_cndmask_b32 v21, v22, v21, vcc
HPOLL:
  s_sleep 32
  buffer_load_dword v23, v21, s[52:55], 0 offen sc1
  s_sub_u32 s3, s3, 1
  s_cmp_eq_u32 s3, 0
  s_waitcnt vmcnt(0)
  s_cbranch_scc1 HGO
  v_cmp_ne_u32 vcc, s100, v23
  s_cbranch_vccnz HPOLL
HGO:
  s_barrier
  s_cmp_lg_u32 s60, 0
  s_cbranch_scc1 HEND
  s_atomic_swap s101, s[26:27], 0
HEND:
  s_endpgm
CODE_END:
.section .rodata,"a"
.p2align 6
.amdhsa_kernel parallel_sum__ssm_conv_h3__dense_activation_relu__prompt_kernel
  .amdhsa_next_free_vgpr 512
  .amdhsa_next_free_sgpr 102
  .amdhsa_accum_offset 256
  .amdhsa_group_segment_fixed_size 0
  .amdhsa_kernarg_size 96
  .amdhsa_user_sgpr_count 2
  .amdhsa_user_sgpr_kernarg_segment_ptr 1
  .amdhsa_system_sgpr_workgroup_id_x 1
  .amdhsa_float_denorm_mode_32 3
.end_amdhsa_kernel
```
